```python
import torch

def _softmax(x, axis=-1):
    return torch.softmax(x, dim=axis)
def _gelu(x):
    return torch.nn.functional.gelu(x, approximate="tanh")
def _silu(x):
    return torch.nn.functional.silu(x)
def _sigmoid(x):
    return torch.sigmoid(x)
def _layernorm(x, axis=-1, eps=1e-5):
    m = x.mean(dim=axis, keepdim=True)
    v = x.var(dim=axis, keepdim=True, unbiased=False)
    return (x - m) / torch.sqrt(v + eps)
def _scatter_add(tgt, idx, src, axis=0):
    return tgt.clone().index_add_(axis, idx, src)
def _segment_sum(src, seg, n):
    out = torch.zeros((n,) + src.shape[1:], dtype=src.dtype)
    return out.index_add_(0, seg, src)
def _pad(x, pw):
    flat = tuple(v for pair in reversed(pw) for v in pair)
    return torch.nn.functional.pad(x, flat)

kernel_name = 'concat_heads__mha_block_cached__sliding_block_cached__decode'

def setup_inputs():

    _w = (lambda a: (lambda t: t.to(torch.bfloat16) if t.is_floating_point() else t)(torch.as_tensor(a)))
    def _A_setup():
        B, Sq, D = 2, 1, 640
        H, Sk, Dh = 32, 4096, 192
        return {
            "x": _w((lambda *s: torch.randn(*s, dtype=torch.bfloat16) * 0.4)(B, Sq, D)),
            "k_cache": _w((lambda *s: torch.randn(*s, dtype=torch.bfloat16) * 3.2)(B, H, Sk, Dh)),
            "v_cache": _w((lambda *s: torch.randn(*s, dtype=torch.bfloat16) * 0.8)(B, H, Sk, Dh)),
            "wq": _w((lambda *s: torch.randn(*s, dtype=torch.bfloat16) * 3.2)(D, H * Dh) * (D ** -0.5)),
            "wo": _w((lambda *s: torch.randn(*s, dtype=torch.bfloat16) * 0.8)(H * Dh, D) * ((H * Dh) ** -0.5)),
        }
    _A_in = _A_setup()

    def _B_setup():
        B, Sq, D = 2, 1, 640
        Hq, Hkv, Sk, Dh = 32, 32, 4096, 192
        assert Hq % Hkv == 0, (Hq, Hkv)
        return {
            "x": _w((lambda *s: torch.randn(*s, dtype=torch.bfloat16) * 0.2)(B, Sq, D)),
            "k_cache": _w((lambda *s: torch.randn(*s, dtype=torch.bfloat16) * 3.2)(B, Hkv, Sk, Dh)),
            "v_cache": _w((lambda *s: torch.randn(*s, dtype=torch.bfloat16) * 1.6)(B, Hkv, Sk, Dh)),
            "wq": _w((lambda *s: torch.randn(*s, dtype=torch.bfloat16) * 3.2)(D, Hq * Dh) * (D ** -0.5)),
            "wo": _w((lambda *s: torch.randn(*s, dtype=torch.bfloat16) * 1.6)(Hq * Dh, D) * ((Hq * Dh) ** -0.5)),
        }
    _B_in = _B_setup()

    return {
        "A_x": _A_in["x"],
        "A_k_cache": _A_in["k_cache"],
        "A_v_cache": _A_in["v_cache"],
        "A_wq": _A_in["wq"],
        "A_wo": _A_in["wo"],
        "B_x": _B_in["x"],
        "B_k_cache": _B_in["k_cache"],
        "B_v_cache": _B_in["v_cache"],
        "B_wq": _B_in["wq"],
        "B_wo": _B_in["wo"],
    }

def reference(A_x, A_k_cache, A_v_cache, A_wq, A_wo, B_x, B_k_cache, B_v_cache, B_wq, B_wo):
    def _A_ref(x, k_cache, v_cache, wq, wo):
        B, Sq, D = x.shape
        H, Dh = 32, 192
        q = (lambda x, *d: x.permute(*d))((x @ wq).reshape(B, Sq, H, Dh), 0, 2, 1, 3)
        scores = torch.einsum("bhqd,bhkd->bhqk", q, k_cache) * (Dh ** -0.5)
        p = _softmax(scores, axis=-1)
        o = torch.einsum("bhqk,bhkd->bhqd", p, v_cache)
        return (lambda x, *d: x.permute(*d))(o, 0, 2, 1, 3).reshape(B, Sq, H * Dh) @ wo

    def _B_ref(x, k_cache, v_cache, wq, wo):
        B, Sq, D = x.shape
        Hq, Dh = 32, 192
        Hkv, Sk = k_cache.shape[1], k_cache.shape[2]
        W = min(4096, max(256, Sk // 4))
        rep = Hq // Hkv
        q = (lambda x, *d: x.permute(*d))((x @ wq).reshape(B, Sq, Hq, Dh), 0, 2, 1, 3)
        k = (lambda x, n, axis: torch.repeat_interleave(x, n, dim=axis))(k_cache[:, :, Sk - W:, :], rep, axis=1)
        v = (lambda x, n, axis: torch.repeat_interleave(x, n, dim=axis))(v_cache[:, :, Sk - W:, :], rep, axis=1)
        scores = torch.einsum("bhqd,bhkd->bhqk", q, k) * (Dh ** -0.5)
        p = _softmax(scores, axis=-1)
        o = torch.einsum("bhqk,bhkd->bhqd", p, v)
        return (lambda x, *d: x.permute(*d))(o, 0, 2, 1, 3).reshape(B, Sq, Hq * Dh) @ wo

    a = _A_ref(A_x, A_k_cache, A_v_cache, A_wq, A_wo)
    b = _B_ref(B_x, B_k_cache, B_v_cache, B_wq, B_wo)
    return torch.concatenate([a, b], axis=-1)
```

```asm
; @launch grid=(256,1,1) block=(448,1,1) lds=163840
.amdgcn_target "amdgcn-amd-amdhsa--gfx950"
.text
.globl concat_heads__mha_block_cached__sliding_block_cached__decode_kernel
.p2align 8
.type concat_heads__mha_block_cached__sliding_block_cached__decode_kernel,@function
concat_heads__mha_block_cached__sliding_block_cached__decode_kernel:
  s_cmp_ge_u32 s2, 256
  s_cbranch_scc1 L_end
  v_lshrrev_b32 v2, 6, v0
  v_mov_b32 v5, 768
  v_readfirstlane_b32 s3, v2
  v_and_b32 v1, 63, v0
  s_cmp_lg_u32 s3, 0
  s_cbranch_scc1 L_noinit
  v_mov_b32 v20, 0
  v_lshl_add_u32 v21, v1, 2, v5
  s_mov_b32 exec_hi, 0
  s_mov_b32 exec_lo, 0xfffff
  ds_write_b32 v21, v20
  s_mov_b64 exec, -1
  s_waitcnt lgkmcnt(0)
L_noinit:
  s_load_dwordx16 s[16:31], s[0:1], 0
  s_load_dwordx8 s[32:39], s[0:1], 64
  s_load_dwordx2 s[40:41], s[0:1], 96
  s_barrier
  s_lshr_b32 s4, s2, 3
  s_and_b32 s12, s2, 7
  s_lshr_b32 s5, s12, 2
  s_and_b32 s6, s12, 3
  v_lshrrev_b32 v3, 4, v1
  v_lshlrev_b32 v7, 4, v1
  s_cmp_lg_u32 s3, 4
  s_cbranch_scc1 L_notl
  s_setprio 2
  v_lshrrev_b32 v9, 3, v1
  v_mul_u32_u24 v9, 0x3000, v9
  v_and_b32 v10, 7, v1
  v_lshl_add_u32 v10, v10, 4, v9
  s_mul_i32 s13, s6, 3
  s_mov_b32 s70, 0
  s_mov_b32 s73, 0
  s_lshl_b32 s8, s5, 5
  s_add_u32 s8, s8, s4
  s_mul_i32 s85, s8, 1572864
  s_mul_i32 s9, s6, 98304
  s_add_u32 s61, s85, s9
  s_add_u32 s61, s61, 1179648
  s_mul_i32 s9, s6, 393216
  s_add_u32 s60, s85, s9
  s_lshl_b32 s74, s5, 3
  s_add_u32 s74, s74, s4
  s_mov_b32 s71, 0
  s_waitcnt lgkmcnt(0)
  s_cmp_eq_u32 s5, 0
  s_cselect_b32 s44, s22, s32
  s_cselect_b32 s45, s23, s33
  s_mov_b32 s46, 7864320
  s_mov_b32 s47, 0x20000
  s_mov_b32 s9, 4096
L_wqu:
  s_and_b32 s8, s13, 3
  s_mul_i32 s8, s8, 1966080
  s_lshr_b32 s10, s13, 2
  s_lshl_b32 s10, s10, 7
  s_add_u32 s8, s8, s10
  s_mul_i32 s10, s4, 384
  s_add_u32 s8, s8, s10
  s_add_u32 s11, s9, 20480
L_wqk:
  s_add_u32 m0, s9, 0
  s_waitcnt vmcnt(31)
  buffer_load_dwordx4 v10, s[44:47], s8 offen nt lds
  s_add_u32 s8, s8, 98304
  s_add_u32 m0, s9, 1024
  s_waitcnt vmcnt(31)
  buffer_load_dwordx4 v10, s[44:47], s8 offen nt lds
  s_add_u32 s8, s8, 98304
  s_add_u32 m0, s9, 2048
  s_waitcnt vmcnt(31)
  buffer_load_dwordx4 v10, s[44:47], s8 offen nt lds
  s_add_u32 s8, s8, 98304
  s_add_u32 m0, s9, 3072
  s_waitcnt vmcnt(31)
  buffer_load_dwordx4 v10, s[44:47], s8 offen nt lds
  s_add_u32 s8, s8, 98304
  s_add_u32 s70, s70, 4
  s_sub_u32 s75, s70, 32
  s_max_i32 s73, s73, s75
  v_mov_b32 v20, s73
  ds_write_b32 v5, v20 offset:52
  s_add_u32 s9, s9, 4096
  s_cmp_lt_u32 s9, s11
  s_cbranch_scc1 L_wqk
  s_add_u32 s13, s13, 1
  s_cmp_lt_u32 s9, 65536
  s_cbranch_scc1 L_wqu
  s_mov_b32 s48, s28
  s_mov_b32 s49, s29
  s_mov_b32 s50, 100663296
  s_mov_b32 s51, 0x20000
  s_mov_b32 s52, s40
  s_mov_b32 s53, s41
  s_mov_b32 s54, 434115584
  s_mov_b32 s55, 0x20000
  s_movk_i32 s7, 1639
  v_add_u32 v15, 0, v1
  v_mul_u32_u24 v16, s7, v15
  v_lshrrev_b32 v16, 16, v16
  v_mul_u32_u24 v17, 40, v16
  v_sub_u32 v17, v15, v17
  v_mul_u32_u24 v16, 0x500, v16
  v_lshl_add_u32 v10, v17, 4, v16
  v_add_u32 v15, 64, v1
  v_mul_u32_u24 v16, s7, v15
  v_lshrrev_b32 v16, 16, v16
  v_mul_u32_u24 v17, 40, v16
  v_sub_u32 v17, v15, v17
  v_mul_u32_u24 v16, 0x500, v16
  v_lshl_add_u32 v11, v17, 4, v16
  v_subrev_u32 v11, 1024, v11
  v_add_u32 v15, 128, v1
  v_mul_u32_u24 v16, s7, v15
  v_lshrrev_b32 v16, 16, v16
  v_mul_u32_u24 v17, 40, v16
  v_sub_u32 v17, v15, v17
  v_mul_u32_u24 v16, 0x500, v16
  v_lshl_add_u32 v12, v17, 4, v16
  v_subrev_u32 v12, 2048, v12
  v_add_u32 v15, 192, v1
  v_mul_u32_u24 v16, s7, v15
  v_lshrrev_b32 v16, 16, v16
  v_mul_u32_u24 v17, 40, v16
  v_sub_u32 v17, v15, v17
  v_mul_u32_u24 v16, 0x500, v16
  v_lshl_add_u32 v13, v17, 4, v16
  v_subrev_u32 v13, 3072, v13
  v_add_u32 v15, 256, v1
  v_mul_u32_u24 v16, s7, v15
  v_lshrrev_b32 v16, 16, v16
  v_mul_u32_u24 v17, 40, v16
  v_sub_u32 v17, v15, v17
  v_mul_u32_u24 v16, 0x500, v16
  v_lshl_add_u32 v14, v17, 4, v16
  s_lshl_b32 s8, s4, 1
  s_lshr_b32 s9, s6, 1
  s_add_u32 s8, s8, s9
  s_mul_i32 s8, s8, 122880
  s_and_b32 s9, s6, 1
  s_mul_i32 s9, s9, 640
  s_add_u32 s13, s8, s9
  s_cmp_eq_u32 s5, 0
  s_cselect_b32 s44, s24, s34
  s_cselect_b32 s45, s25, s35
  s_mov_b32 s14, 4096
L_row:
  s_cmp_lt_u32 s71, 4
  s_cbranch_scc1 L_free_ok
  s_cmp_ge_u32 s71, 6
  s_cbranch_scc1 L_needfree
  ds_read_b32 v21, v5 offset:40
  s_waitcnt lgkmcnt(0)
  v_readfirstlane_b32 s8, v21
  s_cmp_lg_u32 s8, 0
  s_cbranch_scc1 L_free_ok
  s_waitcnt vmcnt(30)
  s_sub_u32 s8, s70, 30
  s_max_i32 s73, s73, s8
  v_mov_b32 v20, s73
  ds_write_b32 v5, v20 offset:52
  s_waitcnt vmcnt(24)
  s_sub_u32 s8, s70, 24
  s_max_i32 s73, s73, s8
  v_mov_b32 v20, s73
  ds_write_b32 v5, v20 offset:52
  s_waitcnt vmcnt(18)
  s_sub_u32 s8, s70, 18
  s_max_i32 s73, s73, s8
  v_mov_b32 v20, s73
  ds_write_b32 v5, v20 offset:52
  s_waitcnt vmcnt(12)
  s_sub_u32 s8, s70, 12
  s_max_i32 s73, s73, s8
  v_mov_b32 v20, s73
  ds_write_b32 v5, v20 offset:52
  s_waitcnt vmcnt(6)
  s_sub_u32 s8, s70, 6
  s_max_i32 s73, s73, s8
  v_mov_b32 v20, s73
  ds_write_b32 v5, v20 offset:52
  s_waitcnt vmcnt(0)
  s_sub_u32 s8, s70, 0
  s_max_i32 s73, s73, s8
  v_mov_b32 v20, s73
  ds_write_b32 v5, v20 offset:52
  s_mov_b32 s72, 0
L_wfree:
  ds_read_b32 v21, v5 offset:40
  s_add_u32 s72, s72, 1
  s_waitcnt lgkmcnt(0)
  v_readfirstlane_b32 s8, v21
  s_cmp_gt_u32 s72, 1048576
  s_cbranch_scc1 L_wfree_done
  s_cmp_lg_u32 s8, 0
  s_cbranch_scc1 L_wfree_done
  s_sleep 1
  s_branch L_wfree
L_wfree_done:
  s_branch L_free_ok
L_needfree:
  s_cmp_ge_u32 s71, 10
  s_cselect_b32 s10, 3, 5
  s_sub_u32 s10, s71, s10
  ds_read_b128 v[22:25], v5 offset:64
  s_waitcnt lgkmcnt(0)
  v_min_u32 v22, v22, v23
  v_min3_u32 v22, v22, v24, v25
  s_nop 0
  v_readfirstlane_b32 s8, v22
  s_cmp_ge_u32 s8, s10
  s_cbranch_scc1 L_free_ok
  s_waitcnt vmcnt(30)
  s_sub_u32 s8, s70, 30
  s_max_i32 s73, s73, s8
  v_mov_b32 v20, s73
  ds_write_b32 v5, v20 offset:52
  s_waitcnt vmcnt(24)
  s_sub_u32 s8, s70, 24
  s_max_i32 s73, s73, s8
  v_mov_b32 v20, s73
  ds_write_b32 v5, v20 offset:52
  s_waitcnt vmcnt(18)
  s_sub_u32 s8, s70, 18
  s_max_i32 s73, s73, s8
  v_mov_b32 v20, s73
  ds_write_b32 v5, v20 offset:52
  s_waitcnt vmcnt(12)
  s_sub_u32 s8, s70, 12
  s_max_i32 s73, s73, s8
  v_mov_b32 v20, s73
  ds_write_b32 v5, v20 offset:52
  s_waitcnt vmcnt(6)
  s_sub_u32 s8, s70, 6
  s_max_i32 s73, s73, s8
  v_mov_b32 v20, s73
  ds_write_b32 v5, v20 offset:52
  s_waitcnt vmcnt(0)
  s_sub_u32 s8, s70, 0
  s_max_i32 s73, s73, s8
  v_mov_b32 v20, s73
  ds_write_b32 v5, v20 offset:52
  s_mov_b32 s72, 0
L_free:
  ds_read_b128 v[22:25], v5 offset:64
  s_add_u32 s72, s72, 1
  s_waitcnt lgkmcnt(0)
  v_min_u32 v22, v22, v23
  v_min3_u32 v22, v22, v24, v25
  s_cmp_gt_u32 s72, 1048576
  s_cbranch_scc1 L_free_ok
  v_readfirstlane_b32 s8, v22
  s_cmp_lt_u32 s8, s10
  s_cbranch_scc1 L_free
L_free_ok:
  s_and_b32 s8, s71, 3
  s_lshr_b32 s9, s71, 2
  s_cmp_lt_u32 s71, 8
  s_cbranch_scc1 L_ordb
  s_sub_u32 s10, s71, 8
  s_lshr_b32 s8, s10, 5
  s_lshl_b32 s8, s8, 4
  s_and_b32 s9, s10, 15
  s_add_u32 s8, s8, s9
  s_lshr_b32 s9, s10, 4
L_ordb:
  s_add_u32 s8, s8, s74
  s_cmp_ge_u32 s71, 8
  s_cbranch_scc1 L_rowA
  s_and_b32 s8, s8, 3
  s_mul_i32 s64, s8, 24576
  s_mov_b32 s65, 24576
  s_bitcmp1_b32 s9, 0
  s_cselect_b32 s48, s30, s28
  s_cselect_b32 s49, s31, s29
  s_add_u32 s64, s64, s61
  s_branch L_rowgo
L_rowA:
  s_and_b32 s8, s8, 15
  s_mul_i32 s64, s8, 24576
  s_mov_b32 s65, 98304
  s_bitcmp1_b32 s9, 0
  s_cselect_b32 s48, s20, s18
  s_cselect_b32 s49, s21, s19
  s_add_u32 s64, s64, s60
L_rowgo:
  s_cmp_ge_u32 s71, 6
  s_cselect_b32 s8, 2, 0
  s_sub_u32 s8, s71, s8
  s_and_b32 s8, s8, 3
  s_mul_i32 s62, s8, 24576
  s_and_b32 s9, s71, 0xfffffffe
  s_cmp_eq_u32 s9, 4
  s_mov_b32 s9, 65536
  s_cselect_b32 s9, 4096, s9
  s_add_u32 s62, s62, s9
  s_add_u32 s63, s62, 24576
  s_cmp_lt_u32 s71, 4
  s_cbranch_scc1 L_halfs
L_halfm:
  s_add_u32 m0, s62, 0
  s_add_u32 s67, s64, 0
  s_waitcnt vmcnt(21)
  buffer_load_dwordx4 v7, s[48:51], s67 offen offset:0 nt lds
  s_waitcnt vmcnt(21)
  buffer_load_dwordx4 v7, s[48:51], s67 offen offset:1024 nt lds
  s_add_u32 s70, s70, 2
  s_sub_u32 s75, s70, 22
  s_max_i32 s73, s73, s75
  v_mov_b32 v20, s73
  ds_write_b32 v5, v20 offset:52
  s_waitcnt vmcnt(21)
  buffer_load_dwordx4 v7, s[48:51], s67 offen offset:2048 nt lds
  s_waitcnt vmcnt(21)
  buffer_load_dwordx4 v7, s[48:51], s67 offen offset:3072 nt lds
  s_add_u32 s70, s70, 2
  s_sub_u32 s75, s70, 22
  s_max_i32 s73, s73, s75
  v_mov_b32 v20, s73
  ds_write_b32 v5, v20 offset:52
  s_add_u32 m0, s62, 4096
  s_add_u32 s67, s64, 4096
  s_waitcnt vmcnt(21)
  buffer_load_dwordx4 v7, s[48:51], s67 offen offset:0 nt lds
  s_waitcnt vmcnt(21)
  buffer_load_dwordx4 v7, s[48:51], s67 offen offset:1024 nt lds
  s_add_u32 s70, s70, 2
  s_sub_u32 s75, s70, 22
  s_max_i32 s73, s73, s75
  v_mov_b32 v20, s73
  ds_write_b32 v5, v20 offset:52
  s_waitcnt vmcnt(21)
  buffer_load_dwordx4 v7, s[48:51], s67 offen offset:2048 nt lds
  s_waitcnt vmcnt(21)
  buffer_load_dwordx4 v7, s[48:51], s67 offen offset:3072 nt lds
  s_add_u32 s70, s70, 2
  s_sub_u32 s75, s70, 22
  s_max_i32 s73, s73, s75
  v_mov_b32 v20, s73
  ds_write_b32 v5, v20 offset:52
  s_add_u32 m0, s62, 8192
  s_add_u32 s67, s64, 8192
  s_waitcnt vmcnt(21)
  buffer_load_dwordx4 v7, s[48:51], s67 offen offset:0 nt lds
  s_waitcnt vmcnt(21)
  buffer_load_dwordx4 v7, s[48:51], s67 offen offset:1024 nt lds
  s_add_u32 s70, s70, 2
  s_sub_u32 s75, s70, 22
  s_max_i32 s73, s73, s75
  v_mov_b32 v20, s73
  ds_write_b32 v5, v20 offset:52
  s_waitcnt vmcnt(21)
  buffer_load_dwordx4 v7, s[48:51], s67 offen offset:2048 nt lds
  s_waitcnt vmcnt(21)
  buffer_load_dwordx4 v7, s[48:51], s67 offen offset:3072 nt lds
  s_add_u32 s70, s70, 2
  s_sub_u32 s75, s70, 22
  s_max_i32 s73, s73, s75
  v_mov_b32 v20, s73
  ds_write_b32 v5, v20 offset:52
  s_add_u32 s62, s62, 12288
  s_add_u32 s64, s64, 12288
  s_cmp_lt_u32 s62, s63
  s_cbranch_scc1 L_halfm
  s_branch L_rowdone
L_halfs:
  s_add_u32 m0, s62, 0
  s_add_u32 s67, s64, 0
  s_waitcnt vmcnt(31)
  buffer_load_dwordx4 v7, s[48:51], s67 offen offset:0 nt lds
  s_waitcnt vmcnt(31)
  buffer_load_dwordx4 v7, s[48:51], s67 offen offset:1024 nt lds
  s_add_u32 s70, s70, 2
  s_sub_u32 s75, s70, 32
  s_max_i32 s73, s73, s75
  v_mov_b32 v20, s73
  ds_write_b32 v5, v20 offset:52
  s_waitcnt vmcnt(31)
  buffer_load_dwordx4 v7, s[48:51], s67 offen offset:2048 nt lds
  s_waitcnt vmcnt(31)
  buffer_load_dwordx4 v7, s[48:51], s67 offen offset:3072 nt lds
  s_add_u32 s70, s70, 2
  s_sub_u32 s75, s70, 32
  s_max_i32 s73, s73, s75
  v_mov_b32 v20, s73
  ds_write_b32 v5, v20 offset:52
  s_add_u32 m0, s62, 4096
  s_add_u32 s67, s64, 4096
  s_waitcnt vmcnt(31)
  buffer_load_dwordx4 v7, s[48:51], s67 offen offset:0 nt lds
  s_waitcnt vmcnt(31)
  buffer_load_dwordx4 v7, s[48:51], s67 offen offset:1024 nt lds
  s_add_u32 s70, s70, 2
  s_sub_u32 s75, s70, 32
  s_max_i32 s73, s73, s75
  v_mov_b32 v20, s73
  ds_write_b32 v5, v20 offset:52
  s_waitcnt vmcnt(31)
  buffer_load_dwordx4 v7, s[48:51], s67 offen offset:2048 nt lds
  s_waitcnt vmcnt(31)
  buffer_load_dwordx4 v7, s[48:51], s67 offen offset:3072 nt lds
  s_add_u32 s70, s70, 2
  s_sub_u32 s75, s70, 32
  s_max_i32 s73, s73, s75
  v_mov_b32 v20, s73
  ds_write_b32 v5, v20 offset:52
  s_add_u32 m0, s62, 8192
  s_add_u32 s67, s64, 8192
  s_waitcnt vmcnt(31)
  buffer_load_dwordx4 v7, s[48:51], s67 offen offset:0 nt lds
  s_waitcnt vmcnt(31)
  buffer_load_dwordx4 v7, s[48:51], s67 offen offset:1024 nt lds
  s_add_u32 s70, s70, 2
  s_sub_u32 s75, s70, 32
  s_max_i32 s73, s73, s75
  v_mov_b32 v20, s73
  ds_write_b32 v5, v20 offset:52
  s_waitcnt vmcnt(31)
  buffer_load_dwordx4 v7, s[48:51], s67 offen offset:2048 nt lds
  s_waitcnt vmcnt(31)
  buffer_load_dwordx4 v7, s[48:51], s67 offen offset:3072 nt lds
  s_add_u32 s70, s70, 2
  s_sub_u32 s75, s70, 32
  s_max_i32 s73, s73, s75
  v_mov_b32 v20, s73
  ds_write_b32 v5, v20 offset:52
  s_add_u32 s62, s62, 12288
  s_add_u32 s64, s64, 12288
  s_cmp_lt_u32 s62, s63
  s_cbranch_scc1 L_halfs
L_rowdone:
  s_add_u32 s71, s71, 1
  s_cmp_lt_u32 s71, 40
  s_cbranch_scc1 L_row
L_wo:
  s_mov_b32 m0, s14
  s_waitcnt vmcnt(21)
  buffer_load_dwordx4 v10, s[44:47], s13 offen offset:0 nt lds
  s_waitcnt vmcnt(21)
  buffer_load_dwordx4 v11, s[44:47], s13 offen offset:1024 nt lds
  s_add_u32 s70, s70, 2
  s_sub_u32 s75, s70, 22
  s_max_i32 s73, s73, s75
  v_mov_b32 v20, s73
  ds_write_b32 v5, v20 offset:52
  s_waitcnt vmcnt(21)
  buffer_load_dwordx4 v12, s[44:47], s13 offen offset:2048 nt lds
  s_waitcnt vmcnt(21)
  buffer_load_dwordx4 v13, s[44:47], s13 offen offset:3072 nt lds
  s_add_u32 m0, s14, 4096
  s_waitcnt vmcnt(21)
  buffer_load_dwordx4 v14, s[44:47], s13 offen nt lds
  s_add_u32 s13, s13, 10240
  s_add_u32 s70, s70, 3
  s_sub_u32 s75, s70, 22
  s_max_i32 s73, s73, s75
  v_mov_b32 v20, s73
  ds_write_b32 v5, v20 offset:52
  s_add_u32 s14, s14, 5120
  s_cmp_lt_u32 s14, 65536
  s_cbranch_scc1 L_wo
  s_waitcnt vmcnt(20)
  s_sub_u32 s8, s70, 20
  s_max_i32 s73, s73, s8
  v_mov_b32 v20, s73
  ds_write_b32 v5, v20 offset:52
  s_waitcnt vmcnt(0)
  s_sub_u32 s8, s70, 0
  s_max_i32 s73, s73, s8
  v_mov_b32 v20, s73
  ds_write_b32 v5, v20 offset:52
  s_cmp_ge_u32 s2, 216
  s_cbranch_scc1 L_lend
  s_mov_b32 s56, s38
  s_mov_b32 s57, s39
  s_mov_b32 s58, 256
  s_mov_b32 s59, 0x20000
  s_mov_b32 s48, s36
  s_mov_b32 s49, s37
  s_mov_b32 s50, 5120
  s_mov_b32 s51, 0x20000
  v_lshrrev_b32 v8, 3, v1
  v_lshlrev_b32 v10, 15, v8
  v_lshlrev_b32 v8, 3, v8
  v_bfe_u32 v11, v1, 2, 1
  v_lshl_add_u32 v10, v11, 13, v10
  v_and_b32 v11, 3, v1
  v_lshl_add_u32 v10, v11, 4, v10
  s_mul_i32 s8, s2, 2428
  s_lshr_b32 s60, s8, 16
  s_mul_i32 s8, s60, 27
  s_sub_u32 s8, s2, s8
  s_lshl_b32 s64, s8, 6
  s_lshl_b32 s9, s60, 11
  s_add_u32 s64, s64, s9
  s_lshr_b32 s9, s60, 2
  s_lshl_b32 s9, s9, 13
  s_add_u32 s64, s64, s9
  s_add_u32 s64, s64, 1572864
  s_add_u32 s65, s64, 262144
  s_add_u32 s66, s64, 524288
  s_add_u32 s67, s64, 786432
  s_mul_i32 s8, s8, 12
  v_mad_u32_u24 v9, v1, 3, s8
  s_mul_i32 s60, s60, 320
  v_add_u32 v11, 0, v9
  v_cmp_le_u32 vcc, 160, v11
  v_lshlrev_b32 v15, 1, v11
  v_add_u32 v6, 2240, v15
  v_cndmask_b32 v15, v15, v6, vcc
  v_cmp_le_u32 vcc, 320, v11
  v_mov_b32 v6, 0x10000
  s_nop 0
  v_cndmask_b32 v12, v15, v6, vcc
  v_add_u32 v11, 1, v9
  v_cmp_le_u32 vcc, 160, v11
  v_lshlrev_b32 v15, 1, v11
  v_add_u32 v6, 2240, v15
  v_cndmask_b32 v15, v15, v6, vcc
  v_cmp_le_u32 vcc, 320, v11
  v_mov_b32 v6, 0x10000
  s_nop 0
  v_cndmask_b32 v13, v15, v6, vcc
  v_add_u32 v11, 2, v9
  v_cmp_le_u32 vcc, 160, v11
  v_lshlrev_b32 v15, 1, v11
  v_add_u32 v6, 2240, v15
  v_cndmask_b32 v15, v15, v6, vcc
  v_cmp_le_u32 vcc, 320, v11
  v_mov_b32 v6, 0x10000
  s_nop 0
  v_cndmask_b32 v14, v15, v6, vcc
  s_mov_b64 s[76:77], -1
  s_mov_b64 s[78:79], -1
  s_mov_b64 s[80:81], -1
  s_mov_b64 s[82:83], -1
  s_mov_b32 s72, 0
L_tags:
  buffer_load_dwordx2 v[40:41], v8, s[56:59], 0 offen offset:0 sc1
  buffer_load_dwordx2 v[42:43], v8, s[56:59], 0 offen offset:64 sc1
  buffer_load_dwordx2 v[44:45], v8, s[56:59], 0 offen offset:128 sc1
  buffer_load_dwordx2 v[46:47], v8, s[56:59], 0 offen offset:192 sc1
L_poll2:
  s_mov_b64 exec, s[76:77]
  s_cbranch_execz L_p2_sk0
  buffer_load_dwordx4 v[24:27], v10, s[52:55], s64 offen sc1
L_p2_sk0:
  s_mov_b64 exec, s[78:79]
  s_cbranch_execz L_p2_sk1
  buffer_load_dwordx4 v[28:31], v10, s[52:55], s65 offen sc1
L_p2_sk1:
  s_mov_b64 exec, s[80:81]
  s_cbranch_execz L_p2_sk2
  buffer_load_dwordx4 v[32:35], v10, s[52:55], s66 offen sc1
L_p2_sk2:
  s_mov_b64 exec, s[82:83]
  s_cbranch_execz L_p2_sk3
  buffer_load_dwordx4 v[36:39], v10, s[52:55], s67 offen sc1
L_p2_sk3:
  s_mov_b64 exec, -1
  s_add_u32 s72, s72, 1
  s_cmp_gt_u32 s72, 131072
  s_waitcnt vmcnt(0)
  s_cbranch_scc1 L_got
  v_and_b32 v16, v41, v43
  v_and_b32 v17, v45, v47
  v_and_b32 v16, v16, v17
  v_cmp_le_i32 vcc, 0, v16
  s_cbranch_vccnz L_tags
  v_cmp_ne_u32 s[76:77], v40, v27
  v_cmp_ne_u32 s[78:79], v42, v31
  v_cmp_ne_u32 s[80:81], v44, v35
  v_cmp_ne_u32 s[82:83], v46, v39
  s_or_b64 vcc, s[76:77], s[78:79]
  s_or_b64 vcc, vcc, s[80:81]
  s_or_b64 vcc, vcc, s[82:83]
  s_cbranch_scc1 L_poll2
L_got:
  v_add_f32 v20, v24, v28
  v_add_f32 v32, v32, v36
  v_add_f32 v21, v25, v29
  v_add_f32 v33, v33, v37
  v_add_f32 v22, v26, v30
  v_add_f32 v34, v34, v38
  v_add_f32 v20, v20, v32
  v_add_f32 v21, v21, v33
  v_add_f32 v22, v22, v34
L_red:
  s_nop 1
  v_add_f32_dpp v72, v20, v20 row_ror:4 row_mask:0xf bank_mask:0xf
  v_add_f32_dpp v73, v21, v21 row_ror:4 row_mask:0xf bank_mask:0xf
  v_add_f32_dpp v74, v22, v22 row_ror:4 row_mask:0xf bank_mask:0xf
  s_nop 0
  v_add_f32_dpp v20, v72, v72 row_ror:8 row_mask:0xf bank_mask:0xf
  v_add_f32_dpp v21, v73, v73 row_ror:8 row_mask:0xf bank_mask:0xf
  v_add_f32_dpp v22, v74, v74 row_ror:8 row_mask:0xf bank_mask:0xf
  v_mov_b32 v72, v20
  v_mov_b32 v73, v21
  v_mov_b32 v74, v22
  s_nop 1
  v_permlane32_swap_b32 v20, v72
  v_permlane32_swap_b32 v21, v73
  v_permlane32_swap_b32 v22, v74
  v_add_f32 v20, v20, v72
  v_add_f32 v21, v21, v73
  v_add_f32 v22, v22, v74
  v_mov_b32 v72, v20
  v_mov_b32 v73, v21
  v_mov_b32 v74, v22
  s_nop 1
  v_permlane16_swap_b32 v20, v72
  v_permlane16_swap_b32 v21, v73
  v_permlane16_swap_b32 v22, v74
  v_add_f32 v20, v20, v72
  v_add_f32 v21, v21, v73
  v_add_f32 v22, v22, v74
  s_mov_b64 exec, 0xf
  v_cvt_pk_bf16_f32 v20, v20, v20
  buffer_store_short v20, v12, s[48:51], s60 offen
  v_cvt_pk_bf16_f32 v21, v21, v21
  buffer_store_short v21, v13, s[48:51], s60 offen
  v_cvt_pk_bf16_f32 v22, v22, v22
  buffer_store_short v22, v14, s[48:51], s60 offen
  s_mov_b64 exec, -1
L_lend:
  s_endpgm
L_notl:
  s_mov_b32 s69, 0x3fb8aa3b
  v_mul_u32_u24 v88, 12, v1
  s_cmp_lt_u32 s3, 4
  s_cbranch_scc1 L_cons
  v_and_b32 v4, 15, v1
  v_and_b32 v8, 31, v1
  v_lshlrev_b32 v8, 4, v8
  v_mov_b32 v12, v88
  s_mov_b32 s74, 0x00030003
  v_mov_b32 v41, 1
  s_cmp_eq_u32 s3, 6
  s_cbranch_scc1 L_qwave
  s_waitcnt lgkmcnt(0)
  s_mov_b32 s52, s40
  s_mov_b32 s53, s41
  s_mov_b32 s54, 434115584
  s_mov_b32 s55, 0x20000
  s_mov_b32 s72, 0
L_t_q:
  ds_read_b32 v20, v5 offset:8
  s_add_u32 s72, s72, 1
  s_waitcnt lgkmcnt(0)
  v_readfirstlane_b32 s8, v20
  s_cmp_gt_u32 s72, 1048576
  s_cbranch_scc1 L_t_q_done
  s_cmp_lg_u32 s8, 0
  s_cbranch_scc1 L_t_q_done
  s_sleep 16
  s_branch L_t_q
L_t_q_done:
  ds_read_b32 v10, v5 offset:32
  s_mov_b32 s79, 1
  s_branch L_tail
L_qwave:
  s_setprio 3
  s_memrealtime s[80:81]
  v_and_b32 v9, 1, v1
  v_mul_u32_u24 v9, 0x500, v9
  v_lshl_add_u32 v13, v3, 4, v9
  s_lshl_b32 s8, s4, 3
  v_mov_b32 v14, s8
  v_bfe_u32 v9, v1, 2, 2
  v_lshl_add_u32 v9, v3, 3, v9
  v_and_b32 v15, 3, v1
  v_lshlrev_b32 v15, 3, v15
  v_lshl_add_u32 v15, v9, 7, v15
  v_mul_u32_u24 v16, 384, v4
  v_lshl_add_u32 v16, v3, 4, v16
  v_mov_b32 v17, v88
  v_lshrrev_b32 v9, 5, v1
  v_and_b32 v19, 31, v1
  v_mul_u32_u24 v19, 6, v19
  v_lshl_add_u32 v42, v9, 7, v19
  v_lshl_add_u32 v18, v9, 10, v8
  v_mul_u32_u24 v43, 384, v9
  v_add_u32 v43, v43, v8
  s_mov_b32 s75, 0x003fffff
  s_mul_i32 s13, s6, 3
  s_mov_b32 s76, 0
  s_waitcnt lgkmcnt(0)
  s_mov_b32 s56, s38
  s_mov_b32 s57, s39
  s_mov_b32 s58, 256
  s_mov_b32 s59, 0x20000
  s_or_b32 s81, s81, 0x80000000
  v_mov_b32 v10, s80
  v_mov_b32 v11, s81
  s_cmp_lg_u32 s12, 0
  s_cbranch_scc1 L_nononce
  s_mov_b64 exec, 1
  buffer_store_dwordx2 v[10:11], v14, s[56:59], 0 offen sc1
  s_mov_b64 exec, -1
L_nononce:
  s_cmp_eq_u32 s5, 0
  s_cselect_b32 s48, s16, s26
  s_cselect_b32 s49, s17, s27
  s_mov_b32 s50, 2560
  s_mov_b32 s51, 0x20000
  s_add_u32 s8, s13, 0
  s_and_b32 s8, s8, 3
  s_mul_i32 s8, s8, 320
  buffer_load_dwordx4 v[20:23], v13, s[48:51], s8 offen offset:0
  buffer_load_dwordx4 v[24:27], v13, s[48:51], s8 offen offset:64
  buffer_load_dwordx4 v[28:31], v13, s[48:51], s8 offen offset:128
  buffer_load_dwordx4 v[32:35], v13, s[48:51], s8 offen offset:192
  buffer_load_dwordx4 v[36:39], v13, s[48:51], s8 offen offset:256
  s_add_u32 s8, s13, 1
  s_and_b32 s8, s8, 3
  s_mul_i32 s8, s8, 320
  buffer_load_dwordx4 v[140:143], v13, s[48:51], s8 offen offset:0
  buffer_load_dwordx4 v[144:147], v13, s[48:51], s8 offen offset:64
  buffer_load_dwordx4 v[148:151], v13, s[48:51], s8 offen offset:128
  buffer_load_dwordx4 v[152:155], v13, s[48:51], s8 offen offset:192
  buffer_load_dwordx4 v[156:159], v13, s[48:51], s8 offen offset:256
  s_add_u32 s8, s13, 2
  s_and_b32 s8, s8, 3
  s_mul_i32 s8, s8, 320
  buffer_load_dwordx4 v[160:163], v13, s[48:51], s8 offen offset:0
  buffer_load_dwordx4 v[164:167], v13, s[48:51], s8 offen offset:64
  buffer_load_dwordx4 v[168:171], v13, s[48:51], s8 offen offset:128
  buffer_load_dwordx4 v[172:175], v13, s[48:51], s8 offen offset:192
  buffer_load_dwordx4 v[176:179], v13, s[48:51], s8 offen offset:256
  s_mov_b32 s52, s40
  s_mov_b32 s53, s41
  s_mov_b32 s54, 434115584
  s_mov_b32 s55, 0x20000
  v_mov_b32 v100, 0
  v_mov_b32 v101, 0
  v_mov_b32 v102, 0
  v_mov_b32 v103, 0
  v_mov_b32 v104, 0
  v_mov_b32 v105, 0
  v_mov_b32 v106, 0
  v_mov_b32 v107, 0
  v_mov_b32 v108, 0
  v_mov_b32 v109, 0
  v_mov_b32 v110, 0
  v_mov_b32 v111, 0
  v_mov_b32 v112, 0
  v_mov_b32 v113, 0
  v_mov_b32 v114, 0
  v_mov_b32 v115, 0
  s_cmp_eq_u32 s12, 0
  s_cbranch_scc1 L_nonce_done
  s_mov_b32 s72, 0
  s_sub_u32 s80, s80, 0x800
L_nonce:
  buffer_load_dwordx2 v[10:11], v14, s[56:59], 0 offen sc1
  s_add_u32 s72, s72, 1
  s_waitcnt vmcnt(0)
  s_cmp_gt_u32 s72, 131072
  s_cbranch_scc1 L_nonce_done
  v_cmp_gt_i32 vcc, 0, v11
  s_cbranch_vccz L_nonce
  v_subrev_u32 v9, s80, v10
  s_cmp_gt_u32 s72, 256
  s_cbranch_scc1 L_nonce_done
  v_cmp_gt_i32 vcc, 0, v9
  s_cbranch_vccnz L_nonce
L_nonce_done:
  ds_write_b32 v5, v10 offset:32
  s_waitcnt vmcnt(0)
L_qunit:
  s_add_u32 s9, s76, 4
  s_mov_b32 s72, 0
L_qw0:
  ds_read_b32 v40, v5 offset:52
  s_add_u32 s72, s72, 1
  s_waitcnt lgkmcnt(0)
  v_readfirstlane_b32 s8, v40
  s_cmp_gt_u32 s72, 1048576
  s_cbranch_scc1 L_qw0_done
  s_cmp_ge_i32 s8, s9
  s_cbranch_scc1 L_qw0_done
  s_sleep 1
  s_branch L_qw0
L_qw0_done:
  ds_read_b64_tr_b16 v[44:45], v15 offset:4096
  ds_read_b64_tr_b16 v[46:47], v15 offset:4608
  ds_read_b64_tr_b16 v[48:49], v15 offset:4128
  ds_read_b64_tr_b16 v[50:51], v15 offset:4640
  ds_read_b64_tr_b16 v[52:53], v15 offset:4160
  ds_read_b64_tr_b16 v[54:55], v15 offset:4672
  ds_read_b64_tr_b16 v[56:57], v15 offset:4192
  ds_read_b64_tr_b16 v[58:59], v15 offset:4704
  s_waitcnt lgkmcnt(0)
  v_mfma_f32_16x16x32_bf16 v[100:103], v[44:47], v[20:23], v[100:103]
  v_mfma_f32_16x16x32_bf16 v[104:107], v[48:51], v[20:23], v[104:107]
  v_mfma_f32_16x16x32_bf16 v[108:111], v[52:55], v[20:23], v[108:111]
  v_mfma_f32_16x16x32_bf16 v[112:115], v[56:59], v[20:23], v[112:115]
  s_add_u32 s9, s76, 8
  s_mov_b32 s72, 0
L_qw1:
  ds_read_b32 v40, v5 offset:52
  s_add_u32 s72, s72, 1
  s_waitcnt lgkmcnt(0)
  v_readfirstlane_b32 s8, v40
  s_cmp_gt_u32 s72, 1048576
  s_cbranch_scc1 L_qw1_done
  s_cmp_ge_i32 s8, s9
  s_cbranch_scc1 L_qw1_done
  s_sleep 1
  s_branch L_qw1
L_qw1_done:
  ds_read_b64_tr_b16 v[44:45], v15 offset:8192
  ds_read_b64_tr_b16 v[46:47], v15 offset:8704
  ds_read_b64_tr_b16 v[48:49], v15 offset:8224
  ds_read_b64_tr_b16 v[50:51], v15 offset:8736
  ds_read_b64_tr_b16 v[52:53], v15 offset:8256
  ds_read_b64_tr_b16 v[54:55], v15 offset:8768
  ds_read_b64_tr_b16 v[56:57], v15 offset:8288
  ds_read_b64_tr_b16 v[58:59], v15 offset:8800
  s_waitcnt lgkmcnt(0)
  v_mfma_f32_16x16x32_bf16 v[100:103], v[44:47], v[24:27], v[100:103]
  v_mfma_f32_16x16x32_bf16 v[104:107], v[48:51], v[24:27], v[104:107]
  v_mfma_f32_16x16x32_bf16 v[108:111], v[52:55], v[24:27], v[108:111]
  v_mfma_f32_16x16x32_bf16 v[112:115], v[56:59], v[24:27], v[112:115]
  s_add_u32 s9, s76, 12
  s_mov_b32 s72, 0
L_qw2:
  ds_read_b32 v40, v5 offset:52
  s_add_u32 s72, s72, 1
  s_waitcnt lgkmcnt(0)
  v_readfirstlane_b32 s8, v40
  s_cmp_gt_u32 s72, 1048576
  s_cbranch_scc1 L_qw2_done
  s_cmp_ge_i32 s8, s9
  s_cbranch_scc1 L_qw2_done
  s_sleep 1
  s_branch L_qw2
L_qw2_done:
  ds_read_b64_tr_b16 v[44:45], v15 offset:12288
  ds_read_b64_tr_b16 v[46:47], v15 offset:12800
  ds_read_b64_tr_b16 v[48:49], v15 offset:12320
  ds_read_b64_tr_b16 v[50:51], v15 offset:12832
  ds_read_b64_tr_b16 v[52:53], v15 offset:12352
  ds_read_b64_tr_b16 v[54:55], v15 offset:12864
  ds_read_b64_tr_b16 v[56:57], v15 offset:12384
  ds_read_b64_tr_b16 v[58:59], v15 offset:12896
  s_waitcnt lgkmcnt(0)
  v_mfma_f32_16x16x32_bf16 v[100:103], v[44:47], v[28:31], v[100:103]
  v_mfma_f32_16x16x32_bf16 v[104:107], v[48:51], v[28:31], v[104:107]
  v_mfma_f32_16x16x32_bf16 v[108:111], v[52:55], v[28:31], v[108:111]
  v_mfma_f32_16x16x32_bf16 v[112:115], v[56:59], v[28:31], v[112:115]
  s_add_u32 s9, s76, 16
  s_mov_b32 s72, 0
L_qw3:
  ds_read_b32 v40, v5 offset:52
  s_add_u32 s72, s72, 1
  s_waitcnt lgkmcnt(0)
  v_readfirstlane_b32 s8, v40
  s_cmp_gt_u32 s72, 1048576
  s_cbranch_scc1 L_qw3_done
  s_cmp_ge_i32 s8, s9
  s_cbranch_scc1 L_qw3_done
  s_sleep 1
  s_branch L_qw3
L_qw3_done:
  ds_read_b64_tr_b16 v[44:45], v15 offset:16384
  ds_read_b64_tr_b16 v[46:47], v15 offset:16896
  ds_read_b64_tr_b16 v[48:49], v15 offset:16416
  ds_read_b64_tr_b16 v[50:51], v15 offset:16928
  ds_read_b64_tr_b16 v[52:53], v15 offset:16448
  ds_read_b64_tr_b16 v[54:55], v15 offset:16960
  ds_read_b64_tr_b16 v[56:57], v15 offset:16480
  ds_read_b64_tr_b16 v[58:59], v15 offset:16992
  s_waitcnt lgkmcnt(0)
  v_mfma_f32_16x16x32_bf16 v[100:103], v[44:47], v[32:35], v[100:103]
  v_mfma_f32_16x16x32_bf16 v[104:107], v[48:51], v[32:35], v[104:107]
  v_mfma_f32_16x16x32_bf16 v[108:111], v[52:55], v[32:35], v[108:111]
  v_mfma_f32_16x16x32_bf16 v[112:115], v[56:59], v[32:35], v[112:115]
  s_add_u32 s9, s76, 20
  s_mov_b32 s72, 0
L_qw4:
  ds_read_b32 v40, v5 offset:52
  s_add_u32 s72, s72, 1
  s_waitcnt lgkmcnt(0)
  v_readfirstlane_b32 s8, v40
  s_cmp_gt_u32 s72, 1048576
  s_cbranch_scc1 L_qw4_done
  s_cmp_ge_i32 s8, s9
  s_cbranch_scc1 L_qw4_done
  s_sleep 1
  s_branch L_qw4
L_qw4_done:
  ds_read_b64_tr_b16 v[44:45], v15 offset:20480
  ds_read_b64_tr_b16 v[46:47], v15 offset:20992
  ds_read_b64_tr_b16 v[48:49], v15 offset:20512
  ds_read_b64_tr_b16 v[50:51], v15 offset:21024
  ds_read_b64_tr_b16 v[52:53], v15 offset:20544
  ds_read_b64_tr_b16 v[54:55], v15 offset:21056
  ds_read_b64_tr_b16 v[56:57], v15 offset:20576
  ds_read_b64_tr_b16 v[58:59], v15 offset:21088
  s_waitcnt lgkmcnt(0)
  v_mfma_f32_16x16x32_bf16 v[100:103], v[44:47], v[36:39], v[100:103]
  v_mfma_f32_16x16x32_bf16 v[104:107], v[48:51], v[36:39], v[104:107]
  v_mfma_f32_16x16x32_bf16 v[108:111], v[52:55], v[36:39], v[108:111]
  v_mfma_f32_16x16x32_bf16 v[112:115], v[56:59], v[36:39], v[112:115]
  s_add_u32 s76, s76, 20
  s_and_b32 s8, s13, 3
  s_cmp_eq_u32 s8, 3
  s_cbranch_scc1 L_qpub
  s_cmp_lt_u32 s76, 60
  s_cbranch_scc1 L_qnext
L_qpub:
  s_lshr_b32 s8, s13, 2
  s_cmp_eq_u32 s8, s6
  s_cselect_b32 s8, 1024, 0
  s_lshl_b32 s9, s2, 11
  s_add_u32 s8, s8, s9
  s_mov_b32 exec_lo, s74
  s_mov_b32 exec_hi, s74
  ds_write_b128 v16, v[100:103] offset:4096
  ds_write_b128 v16, v[104:107] offset:4160
  ds_write_b128 v16, v[108:111] offset:4224
  ds_write_b128 v16, v[112:115] offset:4288
  s_mov_b64 exec, -1
  ds_read_b32 v44, v17 offset:4096
  ds_read_b32 v45, v17 offset:4100
  ds_read_b32 v46, v17 offset:4104
  v_mov_b32 v47, v10
  s_mov_b32 exec_lo, s75
  s_mov_b32 exec_hi, s75
  s_waitcnt lgkmcnt(0)
  buffer_store_dwordx4 v[44:47], v43, s[52:55], s8 offen sc1
  s_mov_b64 exec, -1
  v_mov_b32 v100, 0
  v_mov_b32 v101, 0
  v_mov_b32 v102, 0
  v_mov_b32 v103, 0
  v_mov_b32 v104, 0
  v_mov_b32 v105, 0
  v_mov_b32 v106, 0
  v_mov_b32 v107, 0
  v_mov_b32 v108, 0
  v_mov_b32 v109, 0
  v_mov_b32 v110, 0
  v_mov_b32 v111, 0
  v_mov_b32 v112, 0
  v_mov_b32 v113, 0
  v_mov_b32 v114, 0
  v_mov_b32 v115, 0
L_qnext:
  v_mov_b32 v20, v140
  v_mov_b32 v21, v141
  v_mov_b32 v22, v142
  v_mov_b32 v23, v143
  v_mov_b32 v24, v144
  v_mov_b32 v25, v145
  v_mov_b32 v26, v146
  v_mov_b32 v27, v147
  v_mov_b32 v28, v148
  v_mov_b32 v29, v149
  v_mov_b32 v30, v150
  v_mov_b32 v31, v151
  v_mov_b32 v32, v152
  v_mov_b32 v33, v153
  v_mov_b32 v34, v154
  v_mov_b32 v35, v155
  v_mov_b32 v36, v156
  v_mov_b32 v37, v157
  v_mov_b32 v38, v158
  v_mov_b32 v39, v159
  v_mov_b32 v140, v160
  v_mov_b32 v141, v161
  v_mov_b32 v142, v162
  v_mov_b32 v143, v163
  v_mov_b32 v144, v164
  v_mov_b32 v145, v165
  v_mov_b32 v146, v166
  v_mov_b32 v147, v167
  v_mov_b32 v148, v168
  v_mov_b32 v149, v169
  v_mov_b32 v150, v170
  v_mov_b32 v151, v171
  v_mov_b32 v152, v172
  v_mov_b32 v153, v173
  v_mov_b32 v154, v174
  v_mov_b32 v155, v175
  v_mov_b32 v156, v176
  v_mov_b32 v157, v177
  v_mov_b32 v158, v178
  v_mov_b32 v159, v179
  v_add_u32 v15, 20480, v15
  v_add_u32 v16, 20480, v16
  v_add_u32 v17, 20480, v17
  s_add_u32 s13, s13, 1
  s_cmp_lt_u32 s76, 60
  s_cbranch_scc1 L_qunit
  ds_write_b32 v5, v41 offset:40
  s_lshl_b32 s8, s4, 14
  s_mul_i32 s9, s5, 384
  s_add_u32 s8, s8, s9
  s_add_u32 s60, s8, 1024
  s_add_u32 s61, s60, 4096
  s_add_u32 s62, s60, 8192
  s_add_u32 s63, s60, 12288
  s_mov_b32 s72, 0
L_qd:
  ds_read_b32 v40, v5 offset:52
  s_add_u32 s72, s72, 1
  s_waitcnt lgkmcnt(0)
  v_readfirstlane_b32 s8, v40
  s_cmp_gt_u32 s72, 1048576
  s_cbranch_scc1 L_qd_done
  s_cmp_ge_i32 s8, 90
  s_cbranch_scc1 L_qd_done
  s_sleep 2
  s_branch L_qd
L_qd_done:
  s_mov_b32 s16, s75
  s_mov_b32 s17, s75
  s_mov_b32 s18, s75
  s_mov_b32 s19, s75
  s_mov_b32 s20, s75
  s_mov_b32 s21, s75
  s_mov_b32 s22, s75
  s_mov_b32 s23, s75
  s_mov_b32 s24, s75
  s_mov_b32 s25, s75
  s_mov_b32 s26, s75
  s_mov_b32 s27, s75
  s_mov_b32 s72, 0
L_pollq:
  s_mov_b64 exec, s[16:17]
  s_cbranch_execz L_pq_sk0
  buffer_load_dwordx4 v[52:55], v18, s[52:55], s60 offen offset:0 sc1
L_pq_sk0:
  s_mov_b64 exec, s[18:19]
  s_cbranch_execz L_pq_sk1
  buffer_load_dwordx4 v[56:59], v18, s[52:55], s60 offen offset:2048 sc1
L_pq_sk1:
  s_mov_b64 exec, s[20:21]
  s_cbranch_execz L_pq_sk2
  buffer_load_dwordx4 v[60:63], v18, s[52:55], s61 offen offset:0 sc1
L_pq_sk2:
  s_mov_b64 exec, s[22:23]
  s_cbranch_execz L_pq_sk3
  buffer_load_dwordx4 v[64:67], v18, s[52:55], s62 offen offset:0 sc1
L_pq_sk3:
  s_mov_b64 exec, s[24:25]
  s_cbranch_execz L_pq_sk4
  buffer_load_dwordx4 v[68:71], v18, s[52:55], s62 offen offset:2048 sc1
L_pq_sk4:
  s_mov_b64 exec, s[26:27]
  s_cbranch_execz L_pq_sk5
  buffer_load_dwordx4 v[72:75], v18, s[52:55], s63 offen offset:0 sc1
L_pq_sk5:
  s_mov_b64 exec, -1
  s_mov_b32 exec_lo, s75
  s_mov_b32 exec_hi, s75
  s_add_u32 s72, s72, 1
  s_waitcnt vmcnt(0)
  v_cmp_ne_u32 s[16:17], v10, v55
  v_cmp_ne_u32 s[18:19], v10, v59
  v_cmp_ne_u32 s[20:21], v10, v63
  v_cmp_ne_u32 s[22:23], v10, v67
  v_cmp_ne_u32 s[24:25], v10, v71
  v_cmp_ne_u32 s[26:27], v10, v75
  s_or_b64 vcc, s[16:17], s[18:19]
  s_or_b64 vcc, vcc, s[20:21]
  s_or_b64 vcc, vcc, s[22:23]
  s_or_b64 vcc, vcc, s[24:25]
  s_or_b64 vcc, vcc, s[26:27]
  s_cbranch_scc0 L_pollq_done
  s_sleep 8
  s_cmp_gt_u32 s72, 131072
  s_cbranch_scc0 L_pollq
L_pollq_done:
  s_mov_b64 exec, -1
  s_nop 1
  v_permlane32_swap_b32 v52, v56
  v_permlane32_swap_b32 v53, v57
  v_permlane32_swap_b32 v54, v58
  v_permlane32_swap_b32 v60, v64
  v_permlane32_swap_b32 v61, v65
  v_permlane32_swap_b32 v62, v66
  v_permlane32_swap_b32 v68, v72
  v_permlane32_swap_b32 v69, v73
  v_permlane32_swap_b32 v70, v74
  v_add_f32 v52, v52, v56
  v_add_f32 v53, v53, v57
  v_add_f32 v54, v54, v58
  v_cvt_pk_bf16_f32 v52, v52, v53
  v_cvt_pk_bf16_f32 v53, v54, v54
  v_add_f32 v60, v60, v64
  v_add_f32 v61, v61, v65
  v_add_f32 v62, v62, v66
  v_cvt_pk_bf16_f32 v60, v60, v61
  v_cvt_pk_bf16_f32 v61, v62, v62
  v_add_f32 v68, v68, v72
  v_add_f32 v69, v69, v73
  v_add_f32 v70, v70, v74
  v_cvt_pk_bf16_f32 v68, v68, v69
  v_cvt_pk_bf16_f32 v69, v70, v70
  s_mov_b32 exec_lo, s75
  s_mov_b32 exec_hi, s75
  ds_write_b16 v42, v52 offset:0
  ds_write_b16 v42, v60 offset:256
  ds_write_b16 v42, v68 offset:512
  s_mov_b32 exec_lo, 0x1fffff
  s_mov_b32 exec_hi, 0x1fffff
  ds_write_b16_d16_hi v42, v52 offset:2
  ds_write_b16 v42, v53 offset:4
  ds_write_b16_d16_hi v42, v60 offset:258
  ds_write_b16 v42, v61 offset:260
  ds_write_b16_d16_hi v42, v68 offset:514
  ds_write_b16 v42, v69 offset:516
  s_mov_b64 exec, -1
  ds_write_b32 v5, v41 offset:8
  s_lshl_b32 s15, s2, 12
  s_add_u32 s15, s15, 524288
  s_mov_b32 s72, 0
L_bout:
  ds_read_b32 v20, v5 offset:52
  s_add_u32 s72, s72, 1
  s_waitcnt lgkmcnt(0)
  v_readfirstlane_b32 s8, v20
  s_cmp_gt_u32 s72, 1048576
  s_cbranch_scc1 L_bout_done
  s_cmp_ge_i32 s8, 990
  s_cbranch_scc1 L_bout_done
  s_sleep 16
  s_branch L_bout
L_bout_done:
  s_mov_b32 s72, 0
L_bm:
  ds_read_b32 v20, v5 offset:28
  s_add_u32 s72, s72, 1
  s_waitcnt lgkmcnt(0)
  v_readfirstlane_b32 s8, v20
  s_cmp_gt_u32 s72, 1048576
  s_cbranch_scc1 L_bm_done
  s_cmp_lg_u32 s8, 0
  s_cbranch_scc1 L_bm_done
  s_sleep 1
  s_branch L_bm
L_bm_done:
  ds_read_b128 v[20:23], v7 offset:848
  ds_read_b128 v[24:27], v7 offset:1872
  s_waitcnt lgkmcnt(0)
  buffer_store_dwordx4 v[20:23], v7, s[52:55], s15 offen offset:2048 sc1
  s_mov_b64 exec, 1
  buffer_store_dwordx4 v[24:27], v7, s[52:55], s15 offen offset:3072 sc1
  s_mov_b64 exec, -1
  s_mov_b32 s79, 0
L_tail:
  s_setprio 3
  v_bfe_u32 v9, v1, 2, 2
  v_lshl_add_u32 v9, v3, 3, v9
  v_mul_u32_u24 v9, 640, v9
  v_and_b32 v15, 3, v1
  v_lshl_add_u32 v15, v15, 3, v9
  s_mul_i32 s8, s79, 320
  v_add_u32 v15, s8, v15
  v_lshrrev_b32 v9, 5, v1
  v_lshlrev_b32 v17, 14, v9
  v_add_u32 v16, v17, v8
  s_mul_i32 s8, s79, 12288
  s_add_u32 s8, s8, 90112
  v_and_b32 v9, 1, v1
  v_mul_u32_u24 v9, 192, v9
  v_lshl_add_u32 v18, v3, 4, v9
  v_add_u32 v18, s8, v18
  v_mad_u32_u24 v19, v1, 6, s8
  v_mul_u32_u24 v13, 640, v4
  v_lshl_add_u32 v13, v3, 4, v13
  v_add_u32 v13, s8, v13
  v_add_u32 v12, s8, v12
  s_lshl_b32 s8, s2, 12
  s_lshl_b32 s9, s79, 11
  s_add_u32 s8, s8, s9
  s_add_u32 s14, s8, 1572864
  s_lshl_b32 s8, s4, 15
  s_lshl_b32 s10, s5, 11
  s_add_u32 s8, s8, s10
  s_add_u32 s60, s8, 524288
  s_lshr_b32 s10, s6, 1
  s_lshl_b32 s10, s10, 9
  s_add_u32 s64, s60, s10
  s_add_u32 s61, s60, 4096
  s_add_u32 s65, s64, 4096
  s_add_u32 s62, s60, 8192
  s_add_u32 s66, s64, 8192
  s_add_u32 s63, s60, 12288
  s_add_u32 s67, s64, 12288
  s_mov_b32 s72, 0
L_wo0:
  ds_read_b32 v20, v5 offset:52
  s_add_u32 s72, s72, 1
  s_waitcnt lgkmcnt(0)
  v_readfirstlane_b32 s8, v20
  s_cmp_gt_u32 s72, 1048576
  s_cbranch_scc1 L_wo0_done
  s_cmp_ge_i32 s8, 990
  s_cbranch_scc1 L_wo0_done
  s_sleep 8
  s_branch L_wo0
L_wo0_done:
  s_mov_b32 s72, 0
L_gate:
  ds_read_b32 v20, v5 offset:20
  s_add_u32 s72, s72, 1
  s_waitcnt lgkmcnt(0)
  v_readfirstlane_b32 s8, v20
  s_cmp_gt_u32 s72, 1048576
  s_cbranch_scc1 L_gate_done
  s_cmp_lg_u32 s8, 0
  s_cbranch_scc1 L_gate_done
  s_sleep 1
  s_branch L_gate
L_gate_done:
  s_mov_b32 s76, 0
  s_movk_i32 s78, 1040
  s_mov_b64 s[16:17], -1
  s_mov_b64 s[18:19], -1
  s_mov_b64 s[20:21], -1
  s_mov_b64 s[22:23], -1
  s_mov_b64 s[24:25], -1
  s_mov_b64 s[26:27], -1
  s_mov_b64 s[28:29], -1
  s_mov_b64 s[30:31], -1
L_poll1:
  s_mov_b64 exec, s[16:17]
  s_cbranch_execz L_p1_sk0
  buffer_load_dwordx4 v[20:23], v16, s[52:55], s64 offen sc1
L_p1_sk0:
  s_mov_b64 exec, s[18:19]
  s_cbranch_execz L_p1_sk1
  buffer_load_dwordx4 v[212:215], v17, s[52:55], s60 offen offset:1024 sc1
L_p1_sk1:
  s_mov_b64 exec, s[20:21]
  s_cbranch_execz L_p1_sk2
  buffer_load_dwordx4 v[24:27], v16, s[52:55], s65 offen sc1
L_p1_sk2:
  s_mov_b64 exec, s[22:23]
  s_cbranch_execz L_p1_sk3
  buffer_load_dwordx4 v[216:219], v17, s[52:55], s61 offen offset:1024 sc1
L_p1_sk3:
  s_mov_b64 exec, s[24:25]
  s_cbranch_execz L_p1_sk4
  buffer_load_dwordx4 v[28:31], v16, s[52:55], s66 offen sc1
L_p1_sk4:
  s_mov_b64 exec, s[26:27]
  s_cbranch_execz L_p1_sk5
  buffer_load_dwordx4 v[220:223], v17, s[52:55], s62 offen offset:1024 sc1
L_p1_sk5:
  s_mov_b64 exec, s[28:29]
  s_cbranch_execz L_p1_sk6
  buffer_load_dwordx4 v[32:35], v16, s[52:55], s67 offen sc1
L_p1_sk6:
  s_mov_b64 exec, s[30:31]
  s_cbranch_execz L_p1_sk7
  buffer_load_dwordx4 v[224:227], v17, s[52:55], s63 offen offset:1024 sc1
L_p1_sk7:
  s_mov_b64 exec, -1
L_fr:
  ds_read_b32 v40, v5 offset:52
  s_add_u32 s76, s76, 1
  s_waitcnt lgkmcnt(0)
  v_readfirstlane_b32 s8, v40
  s_cmp_lg_u32 s78, 1040
  s_cbranch_scc1 L_fr0
  s_cmp_lt_i32 s8, s78
  s_cbranch_scc1 L_frdone
  ds_read_b64_tr_b16 v[52:53], v15 offset:4096
  ds_read_b64_tr_b16 v[54:55], v15 offset:6656
  ds_read_b64_tr_b16 v[56:57], v15 offset:4128
  ds_read_b64_tr_b16 v[58:59], v15 offset:6688
  ds_read_b64_tr_b16 v[60:61], v15 offset:4160
  ds_read_b64_tr_b16 v[62:63], v15 offset:6720
  ds_read_b64_tr_b16 v[64:65], v15 offset:4192
  ds_read_b64_tr_b16 v[66:67], v15 offset:6752
  ds_read_b64_tr_b16 v[68:69], v15 offset:4224
  ds_read_b64_tr_b16 v[70:71], v15 offset:6784
  ds_read_b64_tr_b16 v[72:73], v15 offset:4256
  ds_read_b64_tr_b16 v[74:75], v15 offset:6816
  ds_read_b64_tr_b16 v[76:77], v15 offset:4288
  ds_read_b64_tr_b16 v[78:79], v15 offset:6848
  ds_read_b64_tr_b16 v[80:81], v15 offset:4320
  ds_read_b64_tr_b16 v[82:83], v15 offset:6880
  ds_read_b64_tr_b16 v[84:85], v15 offset:4352
  ds_read_b64_tr_b16 v[86:87], v15 offset:6912
  ds_read_b64_tr_b16 v[88:89], v15 offset:4384
  ds_read_b64_tr_b16 v[90:91], v15 offset:6944
  s_add_u32 s78, s78, 20
L_fr0:
  s_cmp_lg_u32 s78, 1060
  s_cbranch_scc1 L_fr1
  s_cmp_lt_i32 s8, s78
  s_cbranch_scc1 L_frdone
  ds_read_b64_tr_b16 v[92:93], v15 offset:24576
  ds_read_b64_tr_b16 v[94:95], v15 offset:27136
  ds_read_b64_tr_b16 v[96:97], v15 offset:24608
  ds_read_b64_tr_b16 v[98:99], v15 offset:27168
  ds_read_b64_tr_b16 v[100:101], v15 offset:24640
  ds_read_b64_tr_b16 v[102:103], v15 offset:27200
  ds_read_b64_tr_b16 v[104:105], v15 offset:24672
  ds_read_b64_tr_b16 v[106:107], v15 offset:27232
  ds_read_b64_tr_b16 v[108:109], v15 offset:24704
  ds_read_b64_tr_b16 v[110:111], v15 offset:27264
  ds_read_b64_tr_b16 v[112:113], v15 offset:24736
  ds_read_b64_tr_b16 v[114:115], v15 offset:27296
  ds_read_b64_tr_b16 v[116:117], v15 offset:24768
  ds_read_b64_tr_b16 v[118:119], v15 offset:27328
  ds_read_b64_tr_b16 v[120:121], v15 offset:24800
  ds_read_b64_tr_b16 v[122:123], v15 offset:27360
  ds_read_b64_tr_b16 v[124:125], v15 offset:24832
  ds_read_b64_tr_b16 v[126:127], v15 offset:27392
  ds_read_b64_tr_b16 v[128:129], v15 offset:24864
  ds_read_b64_tr_b16 v[130:131], v15 offset:27424
  s_add_u32 s78, s78, 20
L_fr1:
  s_cmp_lg_u32 s78, 1080
  s_cbranch_scc1 L_fr2
  s_cmp_lt_i32 s8, s78
  s_cbranch_scc1 L_frdone
  ds_read_b64_tr_b16 v[132:133], v15 offset:45056
  ds_read_b64_tr_b16 v[134:135], v15 offset:47616
  ds_read_b64_tr_b16 v[136:137], v15 offset:45088
  ds_read_b64_tr_b16 v[138:139], v15 offset:47648
  ds_read_b64_tr_b16 v[140:141], v15 offset:45120
  ds_read_b64_tr_b16 v[142:143], v15 offset:47680
  ds_read_b64_tr_b16 v[144:145], v15 offset:45152
  ds_read_b64_tr_b16 v[146:147], v15 offset:47712
  ds_read_b64_tr_b16 v[148:149], v15 offset:45184
  ds_read_b64_tr_b16 v[150:151], v15 offset:47744
  ds_read_b64_tr_b16 v[152:153], v15 offset:45216
  ds_read_b64_tr_b16 v[154:155], v15 offset:47776
  ds_read_b64_tr_b16 v[156:157], v15 offset:45248
  ds_read_b64_tr_b16 v[158:159], v15 offset:47808
  ds_read_b64_tr_b16 v[160:161], v15 offset:45280
  ds_read_b64_tr_b16 v[162:163], v15 offset:47840
  ds_read_b64_tr_b16 v[164:165], v15 offset:45312
  ds_read_b64_tr_b16 v[166:167], v15 offset:47872
  ds_read_b64_tr_b16 v[168:169], v15 offset:45344
  ds_read_b64_tr_b16 v[170:171], v15 offset:47904
  s_add_u32 s78, s78, 20
L_fr2:
L_frdone:
  s_waitcnt vmcnt(0)
  v_cmp_ne_u32 s[16:17], v10, v23
  v_cmp_ne_u32 s[18:19], v10, v215
  v_cmp_ne_u32 s[20:21], v10, v27
  v_cmp_ne_u32 s[22:23], v10, v219
  v_cmp_ne_u32 s[24:25], v10, v31
  v_cmp_ne_u32 s[26:27], v10, v223
  v_cmp_ne_u32 s[28:29], v10, v35
  v_cmp_ne_u32 s[30:31], v10, v227
  s_or_b64 vcc, s[16:17], s[18:19]
  s_or_b64 vcc, vcc, s[20:21]
  s_or_b64 vcc, vcc, s[22:23]
  s_or_b64 vcc, vcc, s[24:25]
  s_or_b64 vcc, vcc, s[26:27]
  s_or_b64 vcc, vcc, s[28:29]
  s_or_b64 vcc, vcc, s[30:31]
  s_cbranch_scc0 L_p1got
  s_cmp_gt_u32 s76, 131072
  s_cbranch_scc0 L_poll1
L_p1got:
  v_max3_f32 v44, v212, v216, v220
  v_max_f32 v44, v44, v224
  v_sub_f32 v212, v212, v44
  v_sub_f32 v216, v216, v44
  v_sub_f32 v220, v220, v44
  v_sub_f32 v224, v224, v44
  v_mul_f32 v212, s69, v212
  v_mul_f32 v216, s69, v216
  v_mul_f32 v220, s69, v220
  v_mul_f32 v224, s69, v224
  v_exp_f32 v212, v212
  v_exp_f32 v216, v216
  v_exp_f32 v220, v220
  v_exp_f32 v224, v224
  s_nop 0
  v_mul_f32 v45, v212, v213
  v_fma_f32 v45, v216, v217, v45
  v_fma_f32 v45, v220, v221, v45
  v_fma_f32 v45, v224, v225, v45
  v_mul_f32 v46, v212, v20
  v_fma_f32 v46, v216, v24, v46
  v_fma_f32 v46, v220, v28, v46
  v_fma_f32 v46, v224, v32, v46
  v_mul_f32 v47, v212, v21
  v_fma_f32 v47, v216, v25, v47
  v_fma_f32 v47, v220, v29, v47
  v_fma_f32 v47, v224, v33, v47
  v_mul_f32 v48, v212, v22
  v_fma_f32 v48, v216, v26, v48
  v_fma_f32 v48, v220, v30, v48
  v_fma_f32 v48, v224, v34, v48
  v_rcp_f32 v45, v45
  s_nop 0
  v_mul_f32 v46, v45, v46
  v_mul_f32 v47, v45, v47
  v_mul_f32 v48, v45, v48
  v_cvt_pk_bf16_f32 v46, v46, v47
  v_cvt_pk_bf16_f32 v47, v48, v48
  ds_write_b16 v19, v46
  ds_write_b16_d16_hi v19, v46 offset:2
  ds_write_b16 v19, v47 offset:4
  ds_read_b128 v[228:231], v18 offset:0
  ds_read_b128 v[232:235], v18 offset:64
  ds_read_b128 v[236:239], v18 offset:128
  s_cmp_gt_u32 s78, 1040
  s_cbranch_scc1 L_have0
  s_mov_b32 s72, 0
L_wl0:
  ds_read_b32 v40, v5 offset:52
  s_add_u32 s72, s72, 1
  s_waitcnt lgkmcnt(0)
  v_readfirstlane_b32 s8, v40
  s_cmp_gt_u32 s72, 1048576
  s_cbranch_scc1 L_wl0_done
  s_cmp_ge_i32 s8, 1040
  s_cbranch_scc1 L_wl0_done
  s_sleep 1
  s_branch L_wl0
L_wl0_done:
  ds_read_b64_tr_b16 v[52:53], v15 offset:4096
  ds_read_b64_tr_b16 v[54:55], v15 offset:6656
  ds_read_b64_tr_b16 v[56:57], v15 offset:4128
  ds_read_b64_tr_b16 v[58:59], v15 offset:6688
  ds_read_b64_tr_b16 v[60:61], v15 offset:4160
  ds_read_b64_tr_b16 v[62:63], v15 offset:6720
  ds_read_b64_tr_b16 v[64:65], v15 offset:4192
  ds_read_b64_tr_b16 v[66:67], v15 offset:6752
  ds_read_b64_tr_b16 v[68:69], v15 offset:4224
  ds_read_b64_tr_b16 v[70:71], v15 offset:6784
  ds_read_b64_tr_b16 v[72:73], v15 offset:4256
  ds_read_b64_tr_b16 v[74:75], v15 offset:6816
  ds_read_b64_tr_b16 v[76:77], v15 offset:4288
  ds_read_b64_tr_b16 v[78:79], v15 offset:6848
  ds_read_b64_tr_b16 v[80:81], v15 offset:4320
  ds_read_b64_tr_b16 v[82:83], v15 offset:6880
  ds_read_b64_tr_b16 v[84:85], v15 offset:4352
  ds_read_b64_tr_b16 v[86:87], v15 offset:6912
  ds_read_b64_tr_b16 v[88:89], v15 offset:4384
  ds_read_b64_tr_b16 v[90:91], v15 offset:6944
L_have0:
  s_waitcnt lgkmcnt(0)
  v_mfma_f32_16x16x32_bf16 v[172:175], v[52:55], v[228:231], 0
  v_mfma_f32_16x16x32_bf16 v[176:179], v[56:59], v[228:231], 0
  s_waitcnt lgkmcnt(12)
  v_mfma_f32_16x16x32_bf16 v[180:183], v[60:63], v[228:231], 0
  v_mfma_f32_16x16x32_bf16 v[184:187], v[64:67], v[228:231], 0
  s_waitcnt lgkmcnt(8)
  v_mfma_f32_16x16x32_bf16 v[188:191], v[68:71], v[228:231], 0
  v_mfma_f32_16x16x32_bf16 v[192:195], v[72:75], v[228:231], 0
  s_waitcnt lgkmcnt(4)
  v_mfma_f32_16x16x32_bf16 v[196:199], v[76:79], v[228:231], 0
  v_mfma_f32_16x16x32_bf16 v[200:203], v[80:83], v[228:231], 0
  s_waitcnt lgkmcnt(0)
  v_mfma_f32_16x16x32_bf16 v[204:207], v[84:87], v[228:231], 0
  v_mfma_f32_16x16x32_bf16 v[208:211], v[88:91], v[228:231], 0
  s_cmp_gt_u32 s78, 1060
  s_cbranch_scc1 L_have1
  s_mov_b32 s72, 0
L_wl1:
  ds_read_b32 v40, v5 offset:52
  s_add_u32 s72, s72, 1
  s_waitcnt lgkmcnt(0)
  v_readfirstlane_b32 s8, v40
  s_cmp_gt_u32 s72, 1048576
  s_cbranch_scc1 L_wl1_done
  s_cmp_ge_i32 s8, 1060
  s_cbranch_scc1 L_wl1_done
  s_sleep 1
  s_branch L_wl1
L_wl1_done:
  ds_read_b64_tr_b16 v[92:93], v15 offset:24576
  ds_read_b64_tr_b16 v[94:95], v15 offset:27136
  ds_read_b64_tr_b16 v[96:97], v15 offset:24608
  ds_read_b64_tr_b16 v[98:99], v15 offset:27168
  ds_read_b64_tr_b16 v[100:101], v15 offset:24640
  ds_read_b64_tr_b16 v[102:103], v15 offset:27200
  ds_read_b64_tr_b16 v[104:105], v15 offset:24672
  ds_read_b64_tr_b16 v[106:107], v15 offset:27232
  ds_read_b64_tr_b16 v[108:109], v15 offset:24704
  ds_read_b64_tr_b16 v[110:111], v15 offset:27264
  ds_read_b64_tr_b16 v[112:113], v15 offset:24736
  ds_read_b64_tr_b16 v[114:115], v15 offset:27296
  ds_read_b64_tr_b16 v[116:117], v15 offset:24768
  ds_read_b64_tr_b16 v[118:119], v15 offset:27328
  ds_read_b64_tr_b16 v[120:121], v15 offset:24800
  ds_read_b64_tr_b16 v[122:123], v15 offset:27360
  ds_read_b64_tr_b16 v[124:125], v15 offset:24832
  ds_read_b64_tr_b16 v[126:127], v15 offset:27392
  ds_read_b64_tr_b16 v[128:129], v15 offset:24864
  ds_read_b64_tr_b16 v[130:131], v15 offset:27424
L_have1:
  s_waitcnt lgkmcnt(15)
  v_mfma_f32_16x16x32_bf16 v[172:175], v[92:95], v[232:235], v[172:175]
  v_mfma_f32_16x16x32_bf16 v[176:179], v[96:99], v[232:235], v[176:179]
  s_waitcnt lgkmcnt(12)
  v_mfma_f32_16x16x32_bf16 v[180:183], v[100:103], v[232:235], v[180:183]
  v_mfma_f32_16x16x32_bf16 v[184:187], v[104:107], v[232:235], v[184:187]
  s_waitcnt lgkmcnt(8)
  v_mfma_f32_16x16x32_bf16 v[188:191], v[108:111], v[232:235], v[188:191]
  v_mfma_f32_16x16x32_bf16 v[192:195], v[112:115], v[232:235], v[192:195]
  s_waitcnt lgkmcnt(4)
  v_mfma_f32_16x16x32_bf16 v[196:199], v[116:119], v[232:235], v[196:199]
  v_mfma_f32_16x16x32_bf16 v[200:203], v[120:123], v[232:235], v[200:203]
  s_waitcnt lgkmcnt(0)
  v_mfma_f32_16x16x32_bf16 v[204:207], v[124:127], v[232:235], v[204:207]
  v_mfma_f32_16x16x32_bf16 v[208:211], v[128:131], v[232:235], v[208:211]
  s_cmp_gt_u32 s78, 1080
  s_cbranch_scc1 L_have2
  s_mov_b32 s72, 0
L_wl2:
  ds_read_b32 v40, v5 offset:52
  s_add_u32 s72, s72, 1
  s_waitcnt lgkmcnt(0)
  v_readfirstlane_b32 s8, v40
  s_cmp_gt_u32 s72, 1048576
  s_cbranch_scc1 L_wl2_done
  s_cmp_ge_i32 s8, 1080
  s_cbranch_scc1 L_wl2_done
  s_sleep 1
  s_branch L_wl2
L_wl2_done:
  ds_read_b64_tr_b16 v[132:133], v15 offset:45056
  ds_read_b64_tr_b16 v[134:135], v15 offset:47616
  ds_read_b64_tr_b16 v[136:137], v15 offset:45088
  ds_read_b64_tr_b16 v[138:139], v15 offset:47648
  ds_read_b64_tr_b16 v[140:141], v15 offset:45120
  ds_read_b64_tr_b16 v[142:143], v15 offset:47680
  ds_read_b64_tr_b16 v[144:145], v15 offset:45152
  ds_read_b64_tr_b16 v[146:147], v15 offset:47712
  ds_read_b64_tr_b16 v[148:149], v15 offset:45184
  ds_read_b64_tr_b16 v[150:151], v15 offset:47744
  ds_read_b64_tr_b16 v[152:153], v15 offset:45216
  ds_read_b64_tr_b16 v[154:155], v15 offset:47776
  ds_read_b64_tr_b16 v[156:157], v15 offset:45248
  ds_read_b64_tr_b16 v[158:159], v15 offset:47808
  ds_read_b64_tr_b16 v[160:161], v15 offset:45280
  ds_read_b64_tr_b16 v[162:163], v15 offset:47840
  ds_read_b64_tr_b16 v[164:165], v15 offset:45312
  ds_read_b64_tr_b16 v[166:167], v15 offset:47872
  ds_read_b64_tr_b16 v[168:169], v15 offset:45344
  ds_read_b64_tr_b16 v[170:171], v15 offset:47904
L_have2:
  s_waitcnt lgkmcnt(15)
  v_mfma_f32_16x16x32_bf16 v[172:175], v[132:135], v[236:239], v[172:175]
  v_mfma_f32_16x16x32_bf16 v[176:179], v[136:139], v[236:239], v[176:179]
  s_waitcnt lgkmcnt(12)
  v_mfma_f32_16x16x32_bf16 v[180:183], v[140:143], v[236:239], v[180:183]
  v_mfma_f32_16x16x32_bf16 v[184:187], v[144:147], v[236:239], v[184:187]
  s_waitcnt lgkmcnt(8)
  v_mfma_f32_16x16x32_bf16 v[188:191], v[148:151], v[236:239], v[188:191]
  v_mfma_f32_16x16x32_bf16 v[192:195], v[152:155], v[236:239], v[192:195]
  s_waitcnt lgkmcnt(4)
  v_mfma_f32_16x16x32_bf16 v[196:199], v[156:159], v[236:239], v[196:199]
  v_mfma_f32_16x16x32_bf16 v[200:203], v[160:163], v[236:239], v[200:203]
  s_waitcnt lgkmcnt(0)
  v_mfma_f32_16x16x32_bf16 v[204:207], v[164:167], v[236:239], v[204:207]
  v_mfma_f32_16x16x32_bf16 v[208:211], v[168:171], v[236:239], v[208:211]
  s_mov_b32 exec_lo, s74
  s_mov_b32 exec_hi, s74
  ds_write_b128 v13, v[172:175] offset:1024
  ds_write_b128 v13, v[176:179] offset:1088
  ds_write_b128 v13, v[180:183] offset:1152
  ds_write_b128 v13, v[184:187] offset:1216
  ds_write_b128 v13, v[188:191] offset:1280
  ds_write_b128 v13, v[192:195] offset:1344
  ds_write_b128 v13, v[196:199] offset:1408
  ds_write_b128 v13, v[200:203] offset:1472
  ds_write_b128 v13, v[204:207] offset:1536
  ds_write_b128 v13, v[208:211] offset:1600
  s_mov_b64 exec, -1
  ds_read_b32 v36, v12 offset:1024
  ds_read_b32 v37, v12 offset:1028
  ds_read_b32 v38, v12 offset:1032
  ds_read_b32 v40, v12 offset:1792
  ds_read_b32 v41, v12 offset:1796
  ds_read_b32 v42, v12 offset:1800
  v_mov_b32 v39, v10
  v_mov_b32 v43, v10
  s_waitcnt lgkmcnt(3)
  buffer_store_dwordx4 v[36:39], v7, s[52:55], s14 offen sc1
  s_mov_b32 exec_hi, 0xfff
  s_waitcnt lgkmcnt(0)
  buffer_store_dwordx4 v[40:43], v7, s[52:55], s14 offen offset:1024 sc1
  s_endpgm
L_cons:
  v_lshrrev_b32 v4, 2, v1
  v_mul_u32_u24 v6, 0x180, v4
  v_and_b32 v8, 3, v1
  v_lshl_add_u32 v6, v8, 3, v6
  v_and_b32 v4, 15, v1
  v_mul_u32_u24 v2, 0x180, v4
  v_lshl_add_u32 v2, v3, 4, v2
  v_lshlrev_b32 v8, 2, v3
  v_cmp_eq_u32 vcc, v4, v8
  s_mul_i32 s62, s3, 6144
  s_add_u32 s62, s62, 65536
  v_cndmask_b32 v4, 0, -1, vcc
  s_mov_b32 s68, 0x3d93cd3a
  s_mov_b32 s70, 0xbfb8aa3b
  v_lshlrev_b32 v93, 4, v3
  v_lshlrev_b32 v150, 2, v1
  s_mul_i32 s74, s3, 784
  s_add_u32 s74, s74, 848
  s_mov_b32 s75, 848
  s_mov_b32 s76, 784
  s_mov_b32 s77, 1
  s_mov_b32 s78, 8
  s_lshl_b32 s8, s3, 2
  v_add_u32 v151, s8, v5
  s_mul_i32 s66, s3, 6
  s_add_u32 s66, s66, 66
  s_lshl_b32 s86, s2, 12
  s_add_u32 s86, s86, 524288
  v_mov_b32 v100, 0
  v_mov_b32 v101, 0
  v_mov_b32 v102, 0
  v_mov_b32 v103, 0
  v_mov_b32 v104, 0
  v_mov_b32 v105, 0
  v_mov_b32 v106, 0
  v_mov_b32 v107, 0
  v_mov_b32 v108, 0
  v_mov_b32 v109, 0
  v_mov_b32 v110, 0
  v_mov_b32 v111, 0
  v_mov_b32 v112, 0
  v_mov_b32 v113, 0
  v_mov_b32 v114, 0
  v_mov_b32 v115, 0
  v_mov_b32 v116, 0
  v_mov_b32 v117, 0
  v_mov_b32 v118, 0
  v_mov_b32 v119, 0
  v_mov_b32 v120, 0
  v_mov_b32 v121, 0
  v_mov_b32 v122, 0
  v_mov_b32 v123, 0
  v_mov_b32 v124, 0
  v_mov_b32 v125, 0
  v_mov_b32 v126, 0
  v_mov_b32 v127, 0
  v_mov_b32 v128, 0
  v_mov_b32 v129, 0
  v_mov_b32 v130, 0
  v_mov_b32 v131, 0
  v_mov_b32 v132, 0
  v_mov_b32 v133, 0
  v_mov_b32 v134, 0
  v_mov_b32 v135, 0
  v_mov_b32 v136, 0
  v_mov_b32 v137, 0
  v_mov_b32 v138, 0
  v_mov_b32 v139, 0
  v_mov_b32 v140, 0
  v_mov_b32 v141, 0
  v_mov_b32 v142, 0
  v_mov_b32 v143, 0
  v_mov_b32 v144, 0
  v_mov_b32 v145, 0
  v_mov_b32 v146, 0
  v_mov_b32 v147, 0
  s_mov_b32 s71, 0
  s_waitcnt lgkmcnt(0)
  s_mov_b32 s52, s40
  s_mov_b32 s53, s41
  s_mov_b32 s54, 434115584
  s_mov_b32 s55, 0x20000
  s_mov_b32 s72, 0
L_wq_ready:
  ds_read_b32 v92, v5 offset:8
  s_add_u32 s72, s72, 1
  s_waitcnt lgkmcnt(0)
  v_readfirstlane_b32 s8, v92
  s_cmp_gt_u32 s72, 1048576
  s_cbranch_scc1 L_wq_ready_done
  s_cmp_lg_u32 s8, 0
  s_cbranch_scc1 L_wq_ready_done
  s_sleep 1
  s_branch L_wq_ready
L_wq_ready_done:
  ds_read_b32 v152, v5 offset:32
L_newq:
  v_mov_b32 v96, 0xff7fffff
  v_mov_b32 v97, 0
  s_mul_i32 s8, s77, 384
  v_add_u32 v91, s8, v93
  ds_read_b128 v[8:11], v91 offset:0
  ds_read_b128 v[12:15], v91 offset:64
  ds_read_b128 v[16:19], v91 offset:128
  ds_read_b128 v[20:23], v91 offset:192
  ds_read_b128 v[24:27], v91 offset:256
  ds_read_b128 v[28:31], v91 offset:320
  s_add_u32 s79, s71, s78
  s_lshr_b32 s79, s79, 1
L_loop:
  s_cmp_ge_u32 s71, 6
  s_cselect_b32 s8, 2, 0
  s_sub_u32 s8, s71, s8
  s_and_b32 s8, s8, 3
  s_mul_i32 s65, s8, 24576
  s_add_u32 s65, s65, s62
  s_and_b32 s8, s71, 0xfffffffe
  s_cmp_eq_u32 s8, 4
  s_cselect_b32 s8, 61440, 0
  s_sub_u32 s65, s65, s8
  s_add_u32 s71, s71, 1
  v_mov_b32 v99, s71
  v_add_u32 v90, s65, v2
  s_mov_b32 s72, 0
L_lwk:
  ds_read_b32 v98, v5 offset:52
  s_add_u32 s72, s72, 1
  s_waitcnt lgkmcnt(0)
  v_readfirstlane_b32 s8, v98
  s_cmp_gt_u32 s72, 1048576
  s_cbranch_scc1 L_lwk_done
  s_cmp_ge_i32 s8, s66
  s_cbranch_scc1 L_lwk_done
  s_sleep 1
  s_branch L_lwk
L_lwk_done:
  ds_read_b128 v[32:35], v90 offset:0
  ds_read_b128 v[36:39], v90 offset:64
  ds_read_b128 v[40:43], v90 offset:128
  ds_read_b128 v[44:47], v90 offset:192
  ds_read_b128 v[48:51], v90 offset:256
  ds_read_b128 v[52:55], v90 offset:320
  s_add_u32 s66, s66, 24
  s_waitcnt lgkmcnt(0)
  ds_write_b32 v151, v99 offset:64
  v_mfma_f32_16x16x32_bf16 v[80:83], v[32:35], v[8:11], 0
  v_mfma_f32_16x16x32_bf16 v[80:83], v[36:39], v[12:15], v[80:83]
  v_mfma_f32_16x16x32_bf16 v[80:83], v[40:43], v[16:19], v[80:83]
  v_mfma_f32_16x16x32_bf16 v[80:83], v[44:47], v[20:23], v[80:83]
  v_mfma_f32_16x16x32_bf16 v[80:83], v[48:51], v[24:27], v[80:83]
  v_mfma_f32_16x16x32_bf16 v[80:83], v[52:55], v[28:31], v[80:83]
  v_mov_b32 v156, v158
  v_mov_b32 v157, v159
  v_mov_b32 v158, v160
  v_mov_b32 v159, v161
  v_mov_b32 v160, v162
  v_mov_b32 v161, v163
  v_mov_b32 v162, v164
  v_mov_b32 v163, v165
  v_mov_b32 v164, v166
  v_mov_b32 v165, v167
  v_mov_b32 v166, v168
  v_mov_b32 v167, v169
  v_mov_b32 v168, v170
  v_mov_b32 v169, v171
  v_mov_b32 v170, v172
  v_mov_b32 v171, v173
  v_mov_b32 v172, v174
  v_mov_b32 v173, v175
  v_mov_b32 v174, v176
  v_mov_b32 v175, v177
  v_mov_b32 v176, v178
  v_mov_b32 v177, v179
  v_mov_b32 v178, v180
  v_mov_b32 v179, v181
  v_mov_b32 v180, v182
  v_mov_b32 v181, v183
  v_mov_b32 v182, v184
  v_mov_b32 v183, v185
  v_mov_b32 v184, v186
  v_mov_b32 v185, v187
  v_cvt_pk_bf16_f32 v84, v80, v81
  v_cvt_pk_bf16_f32 v85, v82, v83
  v_lshlrev_b32 v80, 16, v84
  v_and_b32 v81, 0xffff0000, v84
  v_lshlrev_b32 v82, 16, v85
  v_and_b32 v83, 0xffff0000, v85
  v_mul_f32 v80, s68, v80
  v_mul_f32 v81, s68, v81
  v_mul_f32 v82, s68, v82
  v_mul_f32 v83, s68, v83
  v_cvt_pk_bf16_f32 v186, v80, v81
  v_cvt_pk_bf16_f32 v187, v82, v83
  v_lshlrev_b32 v80, 16, v186
  v_and_b32 v81, 0xffff0000, v186
  v_lshlrev_b32 v82, 16, v187
  v_and_b32 v83, 0xffff0000, v187
  v_max3_f32 v96, v80, v81, v96
  v_max3_f32 v96, v82, v83, v96

  s_cmp_lt_u32 s71, s79
  s_cbranch_scc1 L_loop
L_kdone:
  v_mov_b32 v80, v96
  v_mov_b32 v81, v96
  s_nop 1
  v_permlane32_swap_b32 v80, v81
  v_max_f32 v80, v80, v81
  v_mov_b32 v81, v80
  s_nop 1
  v_permlane16_swap_b32 v80, v81
  v_max_f32 v154, v80, v81
  v_mul_f32 v153, s70, v154

  s_cmp_eq_u32 s77, 0
  s_cbranch_scc1 L_vloop
  v_mov_b32 v156, v180
  v_mov_b32 v157, v181
  v_mov_b32 v158, v182
  v_mov_b32 v159, v183
  v_mov_b32 v160, v184
  v_mov_b32 v161, v185
  v_mov_b32 v162, v186
  v_mov_b32 v163, v187
L_vloop:
  s_cmp_ge_u32 s71, 6
  s_cselect_b32 s8, 2, 0
  s_sub_u32 s8, s71, s8
  s_and_b32 s8, s8, 3
  s_mul_i32 s65, s8, 24576
  s_add_u32 s65, s65, s62
  s_and_b32 s8, s71, 0xfffffffe
  s_cmp_eq_u32 s8, 4
  s_cselect_b32 s8, 61440, 0
  s_sub_u32 s65, s65, s8
  s_add_u32 s71, s71, 1
  v_mov_b32 v99, s71
  v_add_u32 v91, s65, v6
  v_lshlrev_b32 v80, 16, v156
  v_and_b32 v81, 0xffff0000, v156
  v_lshlrev_b32 v82, 16, v157
  v_and_b32 v83, 0xffff0000, v157
  v_fma_f32 v80, v80, s69, v153
  v_fma_f32 v81, v81, s69, v153
  v_fma_f32 v82, v82, s69, v153
  v_fma_f32 v83, v83, s69, v153
  v_exp_f32 v80, v80
  v_exp_f32 v81, v81
  v_exp_f32 v82, v82
  v_exp_f32 v83, v83

  v_mov_b32 v156, v158
  v_mov_b32 v157, v159
  v_mov_b32 v158, v160
  v_mov_b32 v159, v161
  v_mov_b32 v160, v162
  v_mov_b32 v161, v163
  v_mov_b32 v162, v164
  v_mov_b32 v163, v165
  v_mov_b32 v164, v166
  v_mov_b32 v165, v167
  v_mov_b32 v166, v168
  v_mov_b32 v167, v169
  v_mov_b32 v168, v170
  v_mov_b32 v169, v171
  v_mov_b32 v170, v172
  v_mov_b32 v171, v173
  v_mov_b32 v172, v174
  v_mov_b32 v173, v175
  v_mov_b32 v174, v176
  v_mov_b32 v175, v177
  v_mov_b32 v176, v178
  v_mov_b32 v177, v179
  v_mov_b32 v178, v180
  v_mov_b32 v179, v181
  v_mov_b32 v180, v182
  v_mov_b32 v181, v183
  v_mov_b32 v182, v184
  v_mov_b32 v183, v185
  v_mov_b32 v184, v186
  v_mov_b32 v185, v187
  v_add_f32 v89, v80, v81
  v_add_f32 v92, v82, v83
  v_cvt_pk_bf16_f32 v84, v80, v81
  v_cvt_pk_bf16_f32 v85, v82, v83
  v_add_f32 v89, v89, v92
  v_add_f32 v97, v97, v89
  v_mov_b32 v80, v97
  v_mov_b32 v81, v97
  s_nop 1
  v_permlane32_swap_b32 v80, v81
  v_add_f32 v80, v80, v81
  v_mov_b32 v81, v80
  s_nop 1
  v_permlane16_swap_b32 v80, v81
  v_add_f32 v155, v80, v81

  s_mov_b32 s72, 0
L_lwv:
  ds_read_b32 v98, v5 offset:52
  s_add_u32 s72, s72, 1
  s_waitcnt lgkmcnt(0)
  v_readfirstlane_b32 s8, v98
  s_cmp_gt_u32 s72, 1048576
  s_cbranch_scc1 L_lwv_done
  s_cmp_ge_i32 s8, s66
  s_cbranch_scc1 L_lwv_done
  s_sleep 1
  s_branch L_lwv
L_lwv_done:
  ds_read_b64_tr_b16 v[56:57], v91 offset:0
  ds_read_b64_tr_b16 v[58:59], v91 offset:32
  ds_read_b64_tr_b16 v[60:61], v91 offset:64
  ds_read_b64_tr_b16 v[62:63], v91 offset:96
  ds_read_b64_tr_b16 v[64:65], v91 offset:128
  ds_read_b64_tr_b16 v[66:67], v91 offset:160
  ds_read_b64_tr_b16 v[68:69], v91 offset:192
  ds_read_b64_tr_b16 v[70:71], v91 offset:224
  ds_read_b64_tr_b16 v[72:73], v91 offset:256
  ds_read_b64_tr_b16 v[74:75], v91 offset:288
  ds_read_b64_tr_b16 v[76:77], v91 offset:320
  ds_read_b64_tr_b16 v[78:79], v91 offset:352
  s_add_u32 s66, s66, 24
  s_waitcnt lgkmcnt(11)
  v_mfma_f32_16x16x16_bf16 v[100:103], v[56:57], v[84:85], v[100:103]
  s_waitcnt lgkmcnt(10)
  v_mfma_f32_16x16x16_bf16 v[104:107], v[58:59], v[84:85], v[104:107]
  s_waitcnt lgkmcnt(9)
  v_mfma_f32_16x16x16_bf16 v[108:111], v[60:61], v[84:85], v[108:111]
  s_waitcnt lgkmcnt(8)
  v_mfma_f32_16x16x16_bf16 v[112:115], v[62:63], v[84:85], v[112:115]
  s_waitcnt lgkmcnt(7)
  v_mfma_f32_16x16x16_bf16 v[116:119], v[64:65], v[84:85], v[116:119]
  s_waitcnt lgkmcnt(6)
  v_mfma_f32_16x16x16_bf16 v[120:123], v[66:67], v[84:85], v[120:123]
  s_waitcnt lgkmcnt(5)
  v_mfma_f32_16x16x16_bf16 v[124:127], v[68:69], v[84:85], v[124:127]
  s_waitcnt lgkmcnt(4)
  v_mfma_f32_16x16x16_bf16 v[128:131], v[70:71], v[84:85], v[128:131]
  s_waitcnt lgkmcnt(3)
  v_mfma_f32_16x16x16_bf16 v[132:135], v[72:73], v[84:85], v[132:135]
  s_waitcnt lgkmcnt(2)
  v_mfma_f32_16x16x16_bf16 v[136:139], v[74:75], v[84:85], v[136:139]
  s_waitcnt lgkmcnt(1)
  v_mfma_f32_16x16x16_bf16 v[140:143], v[76:77], v[84:85], v[140:143]
  s_waitcnt lgkmcnt(0)
  ds_write_b32 v151, v99 offset:64
  v_mfma_f32_16x16x16_bf16 v[144:147], v[78:79], v[84:85], v[144:147]
  s_cmp_lt_u32 s71, s78
  s_cbranch_scc1 L_vloop
  v_add_u32 v89, s74, v93
  v_mov_b32 v90, s74
  ds_write_b64 v90, v[154:155] offset:768
  s_lshl_b32 s8, s77, 2
  v_add_u32 v91, s8, v5
  v_mov_b32 v92, 1
  s_mov_b32 exec_lo, 0x00010001
  s_mov_b32 exec_hi, 0x00010001
  ds_write_b128 v89, v[100:103] offset:0
  ds_write_b128 v89, v[104:107] offset:64
  ds_write_b128 v89, v[108:111] offset:128
  ds_write_b128 v89, v[112:115] offset:192
  ds_write_b128 v89, v[116:119] offset:256
  ds_write_b128 v89, v[120:123] offset:320
  ds_write_b128 v89, v[124:127] offset:384
  ds_write_b128 v89, v[128:131] offset:448
  ds_write_b128 v89, v[132:135] offset:512
  ds_write_b128 v89, v[136:139] offset:576
  ds_write_b128 v89, v[140:143] offset:640
  ds_write_b128 v89, v[144:147] offset:704
  s_mov_b64 exec, 1
  ds_add_rtn_u32 v92, v91, v92
  s_mov_b64 exec, -1
  v_add_u32 v89, s75, v88
  v_mov_b32 v90, s75
  ds_read_b64 v[48:49], v90 offset:768
  v_add_u32 v90, s76, v90
  ds_read_b64 v[50:51], v90 offset:768
  v_add_u32 v90, s76, v90
  ds_read_b64 v[52:53], v90 offset:768
  v_add_u32 v90, s76, v90
  ds_read_b64 v[54:55], v90 offset:768
  ds_read_b32 v32, v89 offset:0
  ds_read_b32 v33, v89 offset:4
  ds_read_b32 v34, v89 offset:8
  v_add_u32 v89, s76, v89
  ds_read_b32 v36, v89 offset:0
  ds_read_b32 v37, v89 offset:4
  ds_read_b32 v38, v89 offset:8
  v_add_u32 v89, s76, v89
  ds_read_b32 v40, v89 offset:0
  ds_read_b32 v41, v89 offset:4
  ds_read_b32 v42, v89 offset:8
  v_add_u32 v89, s76, v89
  ds_read_b32 v44, v89 offset:0
  ds_read_b32 v45, v89 offset:4
  ds_read_b32 v46, v89 offset:8
  v_mov_b32 v83, v152
  v_mov_b32 v87, v152
  s_waitcnt lgkmcnt(0)
  v_readfirstlane_b32 s8, v92
  s_cmp_lg_u32 s8, 3
  s_cbranch_scc1 L_nomerge
  v_max3_f32 v80, v48, v50, v52
  v_max_f32 v80, v80, v54
  v_sub_f32 v48, v48, v80
  v_sub_f32 v50, v50, v80
  v_sub_f32 v52, v52, v80
  v_sub_f32 v54, v54, v80
  v_mul_f32 v48, s69, v48
  v_mul_f32 v50, s69, v50
  v_mul_f32 v52, s69, v52
  v_mul_f32 v54, s69, v54
  v_exp_f32 v48, v48
  v_exp_f32 v50, v50
  v_exp_f32 v52, v52
  v_exp_f32 v54, v54
  s_nop 0
  v_mul_f32 v81, v48, v49
  v_fma_f32 v81, v50, v51, v81
  v_fma_f32 v81, v52, v53, v81
  v_fma_f32 v81, v54, v55, v81
  v_mul_f32 v84, v48, v32
  v_fma_f32 v84, v50, v36, v84
  v_fma_f32 v84, v52, v40, v84
  v_fma_f32 v84, v54, v44, v84
  v_mul_f32 v85, v48, v33
  v_fma_f32 v85, v50, v37, v85
  v_fma_f32 v85, v52, v41, v85
  v_fma_f32 v85, v54, v45, v85
  v_mul_f32 v86, v48, v34
  v_fma_f32 v86, v50, v38, v86
  v_fma_f32 v86, v52, v42, v86
  v_fma_f32 v86, v54, v46, v86
  s_cmp_eq_u32 s77, 0
  s_cbranch_scc1 L_pubA
  ds_write_b128 v7, v[84:87] offset:848
  s_mov_b64 exec, 1
  ds_write_b128 v7, v[80:83] offset:1872
  s_mov_b64 exec, -1
  s_branch L_pubdone
L_pubA:
  buffer_store_dwordx4 v[84:87], v7, s[52:55], s86 offen sc1
  s_mov_b64 exec, 1
  buffer_store_dwordx4 v[80:83], v7, s[52:55], s86 offen offset:1024 sc1
  s_mov_b64 exec, -1
L_pubdone:
  s_lshl_b32 s8, s77, 3
  v_add_u32 v91, s8, v5
  v_mov_b32 v92, 1
  ds_write_b32 v91, v92 offset:20
L_nomerge:
  s_cmp_eq_u32 s77, 0
  s_cbranch_scc1 L_send
  s_mov_b32 s77, 0
  s_mov_b32 s78, 40
  s_mov_b32 s74, s62
  s_mov_b32 s75, 65536
  s_mov_b32 s76, 6144
  v_mov_b32 v100, 0
  v_mov_b32 v101, 0
  v_mov_b32 v102, 0
  v_mov_b32 v103, 0
  v_mov_b32 v104, 0
  v_mov_b32 v105, 0
  v_mov_b32 v106, 0
  v_mov_b32 v107, 0
  v_mov_b32 v108, 0
  v_mov_b32 v109, 0
  v_mov_b32 v110, 0
  v_mov_b32 v111, 0
  v_mov_b32 v112, 0
  v_mov_b32 v113, 0
  v_mov_b32 v114, 0
  v_mov_b32 v115, 0
  v_mov_b32 v116, 0
  v_mov_b32 v117, 0
  v_mov_b32 v118, 0
  v_mov_b32 v119, 0
  v_mov_b32 v120, 0
  v_mov_b32 v121, 0
  v_mov_b32 v122, 0
  v_mov_b32 v123, 0
  v_mov_b32 v124, 0
  v_mov_b32 v125, 0
  v_mov_b32 v126, 0
  v_mov_b32 v127, 0
  v_mov_b32 v128, 0
  v_mov_b32 v129, 0
  v_mov_b32 v130, 0
  v_mov_b32 v131, 0
  v_mov_b32 v132, 0
  v_mov_b32 v133, 0
  v_mov_b32 v134, 0
  v_mov_b32 v135, 0
  v_mov_b32 v136, 0
  v_mov_b32 v137, 0
  v_mov_b32 v138, 0
  v_mov_b32 v139, 0
  v_mov_b32 v140, 0
  v_mov_b32 v141, 0
  v_mov_b32 v142, 0
  v_mov_b32 v143, 0
  v_mov_b32 v144, 0
  v_mov_b32 v145, 0
  v_mov_b32 v146, 0
  v_mov_b32 v147, 0
  s_branch L_newq
L_send:
L_end:
  s_endpgm
.section .rodata,"a"
.p2align 6
.amdhsa_kernel concat_heads__mha_block_cached__sliding_block_cached__decode_kernel
  .amdhsa_next_free_vgpr 240
  .amdhsa_next_free_sgpr 102
  .amdhsa_accum_offset 240
  .amdhsa_group_segment_fixed_size 0
  .amdhsa_kernarg_size 104
  .amdhsa_user_sgpr_count 2
  .amdhsa_user_sgpr_kernarg_segment_ptr 1
  .amdhsa_system_sgpr_workgroup_id_x 1
  .amdhsa_float_denorm_mode_32 3
.end_amdhsa_kernel
```
